```python
import torch

def _softmax(x, axis=-1):
    return torch.softmax(x, dim=axis)

def _gelu(x):
    return torch.nn.functional.gelu(x, approximate='tanh')

def _silu(x):
    return torch.nn.functional.silu(x)

def _sigmoid(x):
    return torch.sigmoid(x)

def _layernorm(x, axis=-1, eps=1e-05):
    m = x.mean(dim=axis, keepdim=True)
    v = x.var(dim=axis, keepdim=True, unbiased=False)
    return (x - m) / torch.sqrt(v + eps)

def _scatter_add(tgt, idx, src, axis=0):
    return tgt.clone().index_add_(axis, idx, src)

def _segment_sum(src, seg, n):
    out = torch.zeros((n,) + src.shape[1:], dtype=src.dtype)
    return out.index_add_(0, seg, src)

def _pad(x, pw):
    flat = tuple((v for pair in reversed(pw) for v in pair))
    return torch.nn.functional.pad(x, flat)
kernel_name = 'standalone__conformer_conv_module__speech'

def setup_inputs():

    _w = lambda a: (lambda t: t.to(torch.bfloat16) if t.is_floating_point() else t)(torch.as_tensor(a))
    B, T, D, K = (2, 16000, 256, 15)
    return {'x': _w((lambda *s: torch.randn(*s, dtype=torch.bfloat16) * 0.2)(B, T, D)), 'w_pw1': _w((lambda *s: torch.randn(*s, dtype=torch.bfloat16) * 0.2)(D, 2 * D)), 'dw': _w((lambda *s: torch.randn(*s, dtype=torch.bfloat16) * 0.2)(K, D)), 'w_pw2': _w((lambda *s: torch.randn(*s, dtype=torch.bfloat16) * 0.05)(D, D))}

def reference(x, w_pw1, dw, w_pw2):
    B, T, D = x.shape
    K = dw.shape[0]
    h = x @ w_pw1
    a, b = (h[..., :D].clone(), h[..., D:].clone())
    h = a * _sigmoid(b)
    pad = K // 2
    hp = _pad(h, ((0, 0), (pad, pad), (0, 0)))
    out = torch.zeros_like(h)
    for i in range(K):
        out = out + hp[:, i:i + T, :] * dw[i][None, None, :]
    return _silu(out) @ w_pw2
```

```asm
; @launch grid=(250,1,1) block=(512,1,1) lds=163840
.amdgcn_target "amdgcn-amd-amdhsa--gfx950"
.text
.globl standalone__conformer_conv_module__speech_kernel
.p2align 12
.p2align 8
.type standalone__conformer_conv_module__speech_kernel,@function
standalone__conformer_conv_module__speech_kernel:
    s_cmp_ge_u32 s2, 0xfa
    s_cbranch_scc1 L_END
    s_load_dwordx2 s[4:5], s[0:1], 0
    s_load_dwordx2 s[8:9], s[0:1], 8
    s_load_dwordx2 s[12:13], s[0:1], 24
    s_load_dwordx2 s[16:17], s[0:1], 16
    s_load_dwordx2 s[20:21], s[0:1], 32
    v_lshrrev_b32 v1, 6, v0
    s_and_b32 s35, s2, 7
    s_min_u32 s36, s35, 2
    s_mul_i32 s35, s35, 31
    s_lshr_b32 s3, s2, 3
    s_add_u32 s35, s35, s36
    s_add_u32 s3, s3, s35
    s_cmp_ge_u32 s3, 0x7d
    v_readfirstlane_b32 s28, v1
    s_cselect_b32 s35, 0x7d, 0
    s_cselect_b32 s36, 0x7d0000, 0
    s_sub_u32 s31, s3, s35
    s_lshl_b32 s31, s31, 16
    v_bfe_u32 v2, v0, 2, 3
    v_bfe_u32 v3, v0, 5, 1
    v_bfe_u32 v4, v0, 0, 2
    v_bfe_u32 v5, v0, 2, 4
    v_lshlrev_b32 v6, 9, v2
    v_lshl_add_u32 v6, v3, 6, v6
    v_lshl_add_u32 v6, v4, 4, v6
    s_mov_b32 s6, 0x7d0000
    s_mov_b32 s7, 0x20000
    s_mov_b32 s10, 0x40000
    s_mov_b32 s11, 0x20000
    s_mov_b32 s14, 0x20000
    s_mov_b32 s15, 0x20000
    s_mov_b32 s18, 0x1e00
    s_mov_b32 s19, 0x20000
    s_mov_b32 s22, 0x10000
    s_mov_b32 s23, 0x20000
    s_and_b32 s39, s28, 3
    s_mul_i32 s29, s28, 0x2b70
    s_add_u32 s29, s29, 0x12480
    s_mul_i32 s34, s39, 0x28a0
    s_lshl_b32 s37, s39, 13
    s_add_u32 s37, s37, s31
    s_lshr_b32 s35, s39, 1
    s_mul_i32 s38, s35, 0x30c0
    s_mul_i32 s35, s39, 0x820
    s_add_u32 s38, s38, s35
    s_waitcnt lgkmcnt(0)
    s_add_u32 s4, s4, s36
    s_addc_u32 s5, s5, 0
    s_add_u32 s36, s36, s31
    s_add_u32 s20, s20, s36
    s_addc_u32 s21, s21, 0
    s_cmp_lt_u32 s28, 4
    s_cbranch_scc1 L_A
    s_mul_i32 s43, s39, 0x2080
    s_add_u32 s43, s43, 0xa280
    s_sub_u32 s42, s29, 0xadc0
    s_mul_i32 s41, s39, 0x1040
    s_add_u32 s41, s41, 0xe380
    s_lshl_b32 s35, s39, 6
    v_lshlrev_b32 v110, 10, v5
    v_lshl_add_u32 v110, v4, 4, v110
    v_add_u32 v110, s35, v110
    s_add_u32 m0, s43, 0x1040
    s_mov_b32 s30, 0x8000
    buffer_load_dwordx4 v110, s[8:11], s30 offen lds
    s_add_u32 m0, s43, 0x1860
    s_mov_b32 s30, 0xc000
    buffer_load_dwordx4 v110, s[8:11], s30 offen lds
    s_add_u32 m0, s43, 0x1450
    s_mov_b32 s30, 0x8200
    buffer_load_dwordx4 v110, s[8:11], s30 offen lds
    s_add_u32 m0, s43, 0x1c70
    s_mov_b32 s30, 0xc200
    buffer_load_dwordx4 v110, s[8:11], s30 offen lds
    s_add_u32 m0, s38, 0x30c0
    s_add_u32 s30, s37, 0x1080
    buffer_load_dwordx4 v6, s[4:7], s30 offen lds
    s_add_u32 m0, s38, 0x34d0
    s_add_u32 s30, s37, 0x2080
    buffer_load_dwordx4 v6, s[4:7], s30 offen lds
    s_branch L_B2
L_A:
    s_lshl_b32 s35, s39, 6
    v_lshlrev_b32 v27, 9, v5
    v_lshl_add_u32 v27, v4, 4, v27
    v_add_u32 v27, s35, v27
    s_add_u32 m0, s29, 0x2080
    s_nop 0
    buffer_load_dwordx4 v27, s[16:19], 0 offen lds
    s_add_u32 m0, s29, 0xce40
    s_mov_b32 s30, 0x100
    buffer_load_dwordx4 v27, s[16:19], s30 offen lds
    s_add_u32 m0, s38, 0x2080
    s_add_u32 s30, s37, 0x1000
    buffer_load_dwordx4 v6, s[4:7], s30 offen lds
    s_add_u32 m0, s38, 0x2490
    s_add_u32 s30, s37, 0x2000
    buffer_load_dwordx4 v6, s[4:7], s30 offen lds
    s_and_b32 s35, s39, 1
    s_lshl_b32 s35, s35, 12
    s_lshr_b32 s36, s39, 1
    s_lshl_b32 s36, s36, 7
    s_add_u32 s35, s35, s36
    s_add_u32 s35, s35, s31
    s_sub_u32 s35, s35, 0x1000
    v_add_u32 v7, s35, v6
    s_mul_i32 s95, s39, 0x410
    s_mov_b32 m0, s95
    s_nop 0
    buffer_load_dwordx4 v7, s[4:7], 0 offen lds
    s_mul_i32 s43, s39, 0x2080
    s_add_u32 s43, s43, 0xa280
    s_mov_b32 s42, s29
    s_lshl_b32 s35, s39, 6
    v_lshlrev_b32 v110, 10, v5
    v_lshl_add_u32 v110, v4, 4, v110
    v_add_u32 v110, s35, v110
    s_mov_b32 m0, s43
    s_nop 0
    buffer_load_dwordx4 v110, s[8:11], 0 offen lds
    s_add_u32 m0, s43, 0x820
    s_mov_b32 s30, 0x4000
    buffer_load_dwordx4 v110, s[8:11], s30 offen lds
    s_add_u32 m0, s43, 0x410
    s_mov_b32 s30, 0x200
    buffer_load_dwordx4 v110, s[8:11], s30 offen lds
    s_add_u32 m0, s43, 0xc30
    s_mov_b32 s30, 0x4200
    buffer_load_dwordx4 v110, s[8:11], s30 offen lds
    s_lshr_b32 s35, s2, 3
    s_and_b32 s35, s35, 31
    s_lshl_b32 s35, s35, 2
    s_add_u32 s35, s35, s39
    s_lshl_b32 s42, s35, 11
    s_lshl_b32 s43, s35, 10
    v_and_b32 v30, 63, v0
    v_lshlrev_b32 v31, 4, v30
    v_lshlrev_b32 v30, 5, v30
    buffer_load_dword v116, v30, s[8:11], s42 offen
    s_lshr_b32 s35, s2, 3
    s_and_b32 s35, s35, 31
    s_lshl_b32 s35, s35, 11
    s_getpc_b64 s[98:99]
L_PC:
    s_sub_u32 s98, s98, L_PC-standalone__conformer_conv_module__speech_kernel
    s_subb_u32 s99, s99, 0
    v_and_b32 v28, 15, v0
    v_lshl_add_u32 v28, v28, 5, s35
    v_lshl_add_u32 v28, s39, 9, v28
    v_min_u32 v28, L_END-standalone__conformer_conv_module__speech_kernel, v28
    v_mov_b32 v29, s99
    v_add_co_u32 v28, vcc, s98, v28
    s_nop 1
    v_addc_co_u32 v29, vcc, 0, v29, vcc
    global_load_dword v117, v[28:29], off
    v_bfe_u32 v8, v0, 0, 1
    v_bfe_u32 v9, v0, 1, 1
    v_bfe_u32 v10, v0, 2, 1
    v_bfe_u32 v11, v0, 3, 1
    v_bfe_u32 v12, v0, 4, 1
    v_bfe_u32 v13, v0, 2, 2
    v_bfe_u32 v14, v0, 0, 4
    v_bfe_u32 v15, v0, 0, 5
    v_bfe_u32 v16, v0, 0, 3
    v_bfe_u32 v17, v0, 4, 2
    v_bfe_u32 v18, v0, 3, 3
    v_bfe_u32 v19, v0, 3, 2
    v_bfe_u32 v20, v0, 0, 6
    v_mul_u32_u24 v118, 0x820, v10
    s_mov_b32 s36, 0x410
    v_mad_u32_u24 v118, v12, s36, v118
    v_lshl_add_u32 v118, v11, 8, v118
    v_lshl_add_u32 v118, v4, 6, v118
    v_lshl_add_u32 v118, v3, 4, v118
    v_mul_u32_u24 v108, 0x410, v11
    v_lshl_add_u32 v108, v16, 6, v108
    v_lshl_add_u32 v108, v12, 5, v108
    v_lshl_add_u32 v108, v3, 4, v108
    v_lshlrev_b32 v124, 9, v3
    v_lshl_add_u32 v124, v13, 6, v124
    v_lshl_add_u32 v124, v4, 3, v124
    v_mul_u32_u24 v109, 0x820, v12
    v_add_u32 v109, v124, v109
    v_add_u32 v109, s29, v109
    v_lshl_add_u32 v124, v12, 5, v124
    s_mul_i32 s41, s39, 0x2080
    s_add_u32 s41, s41, 0xa280
    s_sub_u32 s94, s41, s29
    v_add_u32 v109, s94, v109
    v_add_u32 v111, s41, v124
    v_bcnt_u32_b32 v25, v2, 0
    v_and_b32 v25, 1, v25
    v_lshlrev_b32 v24, 1, v3
    v_lshl_add_u32 v24, v19, 2, v24
    v_add_u32 v24, v25, v24
    s_add_u32 s35, s29, 0x248e
    v_lshlrev_b32 v25, 1, v4
    v_sub_u32 v25, s35, v25
    v_mul_u32_u24 v112, 40, v24
    v_add_u32 v112, v25, v112
    s_add_u32 s35, s29, 32
    v_mul_u32_u24 v119, 0xb0, v15
    v_lshl_add_u32 v119, v3, 5, v119
    v_add_u32 v119, s35, v119
    v_mul_u32_u24 v113, 0xb0, v14
    v_lshl_add_u32 v113, v17, 3, v113
    v_add_u32 v113, s35, v113
    v_mul_u32_u24 v120, 0xb0, v24
    v_lshl_add_u32 v120, v4, 4, v120
    v_add_u32 v120, s29, v120
    s_add_u32 s35, s29, 0x1640
    v_lshlrev_b32 v121, 6, v24
    v_lshl_add_u32 v121, v4, 4, v121
    v_add_u32 v121, s35, v121
    s_lshl_b32 s35, s28, 7
    v_lshlrev_b32 v122, 9, v5
    v_lshl_add_u32 v122, v4, 4, v122
    v_add_u32 v122, s35, v122
    v_lshlrev_b32 v123, 9, v3
    v_lshl_add_u32 v123, v13, 6, v123
    v_lshl_add_u32 v123, v8, 5, v123
    v_lshl_add_u32 v123, v12, 4, v123
    v_lshl_add_u32 v123, v9, 3, v123
    v_add_u32 v123, s34, v123
    v_add_u32 v125, 0x13ac0, v124
    v_add_u32 v126, 0x1e880, v124
    s_add_u32 s40, s34, 0x107f
    s_and_b32 s40, s40, 0xffffff80
    v_lshlrev_b32 v25, 1, v3
    v_xor_b32 v25, v25, v16
    v_lshlrev_b32 v127, 7, v15
    v_lshl_add_u32 v127, v25, 4, v127
    v_add_u32 v127, s40, v127
    v_lshlrev_b32 v114, 4, v20
    v_add_u32 v114, s40, v114
    v_xor_b32 v25, v16, v18
    v_lshlrev_b32 v115, 9, v18
    v_lshl_add_u32 v115, v25, 4, v115
    v_add_u32 v115, s35, v115
    s_mov_b32 s32, 0xbfb8aa3b
    s_mov_b32 s33, 0xbf317218
    s_add_u32 s35, s29, 0x2490
    v_mul_u32_u24 v26, 40, v15
    v_lshl_add_u32 v26, v3, 4, v26
    v_add_u32 v26, s35, v26
    v_min_u32 v27, 32, v20
    s_add_u32 s35, s29, 0x2488
    v_mul_u32_u24 v27, 40, v27
    v_add_u32 v27, s35, v27
    v_mov_b32 v28, 0
    v_mov_b32 v29, 0
    s_add_u32 s35, s29, 0x2080
    v_add_u32 v40, s35, v124
    ds_write_b64 v27, v[28:29]
    s_waitcnt vmcnt(10)
    ds_read_b64_tr_b16 v[32:33], v40
    ds_read_b64_tr_b16 v[34:35], v40 offset:256
    ds_write_b64 v27, v[28:29] offset:44480
    s_waitcnt vmcnt(9)
    ds_read_b64_tr_b16 v[36:37], v40 offset:44480
    ds_read_b64_tr_b16 v[38:39], v40 offset:44736
    s_waitcnt lgkmcnt(4)
    ds_write_b64 v26, v[32:33]
    s_waitcnt lgkmcnt(4)
    ds_write_b64 v26, v[34:35] offset:8
    s_waitcnt lgkmcnt(3)
    ds_write_b64 v26, v[36:37] offset:44480
    s_waitcnt lgkmcnt(3)
    ds_write_b64 v26, v[38:39] offset:44488
    s_setprio 2
    s_waitcnt vmcnt(2)
    s_barrier
    ds_read_b128 v[80:83], v118 offset:8320
    ds_read_b64_tr_b16 a[0:1], v111
    ds_read_b64_tr_b16 a[2:3], v111 offset:256
    ds_read_b128 v[96:99], v108
    ds_read_b64_tr_b16 v[100:101], v109
    ds_read_b64_tr_b16 v[102:103], v109 offset:256
    ds_read_b128 v[84:87], v118 offset:24960
    ds_read_b64_tr_b16 v[104:105], v109 offset:32
    ds_read_b64_tr_b16 v[106:107], v109 offset:288
    ds_read_b128 v[88:91], v118 offset:8352
    ds_read_b64_tr_b16 a[8:9], v111 offset:2080
    ds_read_b64_tr_b16 a[10:11], v111 offset:2336
    ds_read_b128 v[92:95], v118 offset:24992
    s_waitcnt lgkmcnt(10)
    v_mfma_f32_32x32x16_bf16 v[16:31], v[80:83], a[0:3], 0
    ds_read_b64_tr_b16 a[4:5], v111 offset:1040
    ds_read_b64_tr_b16 a[6:7], v111 offset:1296
    s_waitcnt lgkmcnt(9)
    v_mfma_f32_16x16x32_bf16 v[0:3], v[96:99], v[100:103], 0
    s_waitcnt lgkmcnt(8)
    v_mfma_f32_32x32x16_bf16 v[48:63], v[84:87], a[0:3], 0
    ds_read_b64_tr_b16 v[100:101], v109 offset:1040
    ds_read_b64_tr_b16 v[102:103], v109 offset:1296
    ds_read_b64_tr_b16 a[12:13], v111 offset:3120
    ds_read_b64_tr_b16 a[14:15], v111 offset:3376
    s_waitcnt lgkmcnt(10)
    v_mfma_f32_16x16x32_bf16 v[4:7], v[96:99], v[104:107], 0
    ds_read_b64_tr_b16 v[104:105], v109 offset:1072
    ds_read_b64_tr_b16 v[106:107], v109 offset:1328
    s_waitcnt lgkmcnt(9)
    v_mfma_f32_32x32x16_bf16 v[16:31], v[88:91], a[8:11], v[16:31]
    s_waitcnt lgkmcnt(6)
    v_mfma_f32_32x32x16_bf16 v[48:63], v[92:95], a[8:11], v[48:63]
    v_mfma_f32_32x32x16_bf16 v[32:47], v[80:83], a[4:7], 0
    s_waitcnt lgkmcnt(0)
    s_barrier
    ds_read_b128 v[80:83], v118 offset:8832
    ds_read_b64_tr_b16 a[16:17], v111 offset:4160
    ds_read_b64_tr_b16 a[18:19], v111 offset:4416
    v_mfma_f32_16x16x32_bf16 v[8:11], v[96:99], v[100:103], 0
    v_mfma_f32_32x32x16_bf16 v[64:79], v[84:87], a[4:7], 0
    ds_read_b128 v[84:87], v118 offset:25472
    ds_read_b64_tr_b16 v[100:101], v109 offset:4160
    ds_read_b64_tr_b16 v[102:103], v109 offset:4416
    v_mfma_f32_16x16x32_bf16 v[12:15], v[96:99], v[104:107], 0
    ds_read_b128 v[96:99], v108 offset:512
    v_mfma_f32_32x32x16_bf16 v[32:47], v[88:91], a[12:15], v[32:47]
    ds_read_b128 v[88:91], v118 offset:8864
    ds_read_b64_tr_b16 v[104:105], v109 offset:4192
    ds_read_b64_tr_b16 v[106:107], v109 offset:4448
    v_mfma_f32_32x32x16_bf16 v[64:79], v[92:95], a[12:15], v[64:79]
    ds_read_b128 v[92:95], v118 offset:25504
    ds_read_b64_tr_b16 a[24:25], v111 offset:6240
    ds_read_b64_tr_b16 a[26:27], v111 offset:6496
    s_waitcnt lgkmcnt(10)
    v_mfma_f32_32x32x16_bf16 v[16:31], v[80:83], a[16:19], v[16:31]
    ds_read_b64_tr_b16 a[20:21], v111 offset:5200
    ds_read_b64_tr_b16 a[22:23], v111 offset:5456
    s_waitcnt lgkmcnt(8)
    v_mfma_f32_16x16x32_bf16 v[0:3], v[96:99], v[100:103], v[0:3]
    v_mfma_f32_32x32x16_bf16 v[48:63], v[84:87], a[16:19], v[48:63]
    ds_read_b64_tr_b16 v[100:101], v109 offset:5200
    ds_read_b64_tr_b16 v[102:103], v109 offset:5456
    ds_read_b64_tr_b16 a[28:29], v111 offset:7280
    ds_read_b64_tr_b16 a[30:31], v111 offset:7536
    s_waitcnt lgkmcnt(9)
    v_mfma_f32_16x16x32_bf16 v[4:7], v[96:99], v[104:107], v[4:7]
    ds_read_b64_tr_b16 v[104:105], v109 offset:5232
    ds_read_b64_tr_b16 v[106:107], v109 offset:5488
    s_waitcnt lgkmcnt(8)
    v_mfma_f32_32x32x16_bf16 v[16:31], v[88:91], a[24:27], v[16:31]
    v_mfma_f32_32x32x16_bf16 v[48:63], v[92:95], a[24:27], v[48:63]
    s_waitcnt lgkmcnt(6)
    v_mfma_f32_32x32x16_bf16 v[32:47], v[80:83], a[20:23], v[32:47]
    s_waitcnt lgkmcnt(0)
    s_barrier
    v_subrev_u32 v111, s94, v111
    v_subrev_u32 v109, s94, v109
    ds_read_b128 v[80:83], v118 offset:12480
    ds_read_b64_tr_b16 a[32:33], v111
    ds_read_b64_tr_b16 a[34:35], v111 offset:256
    v_mfma_f32_16x16x32_bf16 v[8:11], v[96:99], v[100:103], v[8:11]
    v_mfma_f32_32x32x16_bf16 v[64:79], v[84:87], a[20:23], v[64:79]
    ds_read_b128 v[84:87], v118 offset:29120
    ds_read_b64_tr_b16 v[100:101], v109
    ds_read_b64_tr_b16 v[102:103], v109 offset:256
    v_mfma_f32_16x16x32_bf16 v[12:15], v[96:99], v[104:107], v[12:15]
    ds_read_b128 v[96:99], v108 offset:2080
    v_mfma_f32_32x32x16_bf16 v[32:47], v[88:91], a[28:31], v[32:47]
    ds_read_b128 v[88:91], v118 offset:12512
    ds_read_b64_tr_b16 v[104:105], v109 offset:32
    ds_read_b64_tr_b16 v[106:107], v109 offset:288
    v_mfma_f32_32x32x16_bf16 v[64:79], v[92:95], a[28:31], v[64:79]
    ds_read_b128 v[92:95], v118 offset:29152
    ds_read_b64_tr_b16 a[40:41], v111 offset:2080
    ds_read_b64_tr_b16 a[42:43], v111 offset:2336
    s_waitcnt lgkmcnt(10)
    v_mfma_f32_32x32x16_bf16 v[16:31], v[80:83], a[32:35], v[16:31]
    ds_read_b64_tr_b16 a[36:37], v111 offset:1040
    ds_read_b64_tr_b16 a[38:39], v111 offset:1296
    s_waitcnt lgkmcnt(8)
    v_mfma_f32_16x16x32_bf16 v[0:3], v[96:99], v[100:103], v[0:3]
    v_mfma_f32_32x32x16_bf16 v[48:63], v[84:87], a[32:35], v[48:63]
    ds_read_b64_tr_b16 v[100:101], v109 offset:1040
    ds_read_b64_tr_b16 v[102:103], v109 offset:1296
    ds_read_b64_tr_b16 a[44:45], v111 offset:3120
    ds_read_b64_tr_b16 a[46:47], v111 offset:3376
    s_waitcnt lgkmcnt(9)
    v_mfma_f32_16x16x32_bf16 v[4:7], v[96:99], v[104:107], v[4:7]
    ds_read_b64_tr_b16 v[104:105], v109 offset:1072
    ds_read_b64_tr_b16 v[106:107], v109 offset:1328
    s_waitcnt lgkmcnt(8)
    v_mfma_f32_32x32x16_bf16 v[16:31], v[88:91], a[40:43], v[16:31]
    v_mfma_f32_32x32x16_bf16 v[48:63], v[92:95], a[40:43], v[48:63]
    s_waitcnt lgkmcnt(6)
    v_mfma_f32_32x32x16_bf16 v[32:47], v[80:83], a[36:39], v[32:47]
    s_waitcnt lgkmcnt(0)
    s_barrier
    ds_read_b128 v[80:83], v118 offset:12992
    ds_read_b64_tr_b16 a[48:49], v111 offset:4160
    ds_read_b64_tr_b16 a[50:51], v111 offset:4416
    v_mfma_f32_16x16x32_bf16 v[8:11], v[96:99], v[100:103], v[8:11]
    v_mfma_f32_32x32x16_bf16 v[64:79], v[84:87], a[36:39], v[64:79]
    ds_read_b128 v[84:87], v118 offset:29632
    ds_read_b64_tr_b16 v[100:101], v109 offset:4160
    ds_read_b64_tr_b16 v[102:103], v109 offset:4416
    v_mfma_f32_16x16x32_bf16 v[12:15], v[96:99], v[104:107], v[12:15]
    ds_read_b128 v[96:99], v108 offset:2592
    v_mfma_f32_32x32x16_bf16 v[32:47], v[88:91], a[44:47], v[32:47]
    ds_read_b128 v[88:91], v118 offset:13024
    ds_read_b64_tr_b16 v[104:105], v109 offset:4192
    ds_read_b64_tr_b16 v[106:107], v109 offset:4448
    v_mfma_f32_32x32x16_bf16 v[64:79], v[92:95], a[44:47], v[64:79]
    ds_read_b128 v[92:95], v118 offset:29664
    ds_read_b64_tr_b16 a[56:57], v111 offset:6240
    ds_read_b64_tr_b16 a[58:59], v111 offset:6496
    s_waitcnt lgkmcnt(10)
    v_mfma_f32_32x32x16_bf16 v[16:31], v[80:83], a[48:51], v[16:31]
    ds_read_b64_tr_b16 a[52:53], v111 offset:5200
    ds_read_b64_tr_b16 a[54:55], v111 offset:5456
    s_waitcnt lgkmcnt(8)
    v_mfma_f32_16x16x32_bf16 v[0:3], v[96:99], v[100:103], v[0:3]
    v_mfma_f32_32x32x16_bf16 v[48:63], v[84:87], a[48:51], v[48:63]
    ds_read_b64_tr_b16 v[100:101], v109 offset:5200
    ds_read_b64_tr_b16 v[102:103], v109 offset:5456
    ds_read_b64_tr_b16 a[60:61], v111 offset:7280
    ds_read_b64_tr_b16 a[62:63], v111 offset:7536
    s_waitcnt lgkmcnt(9)
    v_mfma_f32_16x16x32_bf16 v[4:7], v[96:99], v[104:107], v[4:7]
    ds_read_b64_tr_b16 v[104:105], v109 offset:5232
    ds_read_b64_tr_b16 v[106:107], v109 offset:5488
    s_waitcnt lgkmcnt(8)
    v_mfma_f32_32x32x16_bf16 v[16:31], v[88:91], a[56:59], v[16:31]
    v_mfma_f32_32x32x16_bf16 v[48:63], v[92:95], a[56:59], v[48:63]
    s_waitcnt lgkmcnt(6)
    v_mfma_f32_32x32x16_bf16 v[32:47], v[80:83], a[52:55], v[32:47]
    s_waitcnt lgkmcnt(0)
    s_barrier
    v_add_u32 v111, s94, v111
    v_add_u32 v109, s94, v109
    ds_read_b128 v[80:83], v118 offset:16640
    ds_read_b64_tr_b16 a[64:65], v111
    ds_read_b64_tr_b16 a[66:67], v111 offset:256
    v_mfma_f32_16x16x32_bf16 v[8:11], v[96:99], v[100:103], v[8:11]
    v_mfma_f32_32x32x16_bf16 v[64:79], v[84:87], a[52:55], v[64:79]
    ds_read_b128 v[84:87], v118 offset:33280
    ds_read_b64_tr_b16 v[100:101], v109
    ds_read_b64_tr_b16 v[102:103], v109 offset:256
    v_mfma_f32_16x16x32_bf16 v[12:15], v[96:99], v[104:107], v[12:15]
    ds_read_b128 v[96:99], v108 offset:4160
    v_mfma_f32_32x32x16_bf16 v[32:47], v[88:91], a[60:63], v[32:47]
    ds_read_b128 v[88:91], v118 offset:16672
    ds_read_b64_tr_b16 v[104:105], v109 offset:32
    ds_read_b64_tr_b16 v[106:107], v109 offset:288
    v_mfma_f32_32x32x16_bf16 v[64:79], v[92:95], a[60:63], v[64:79]
    ds_read_b128 v[92:95], v118 offset:33312
    ds_read_b64_tr_b16 a[72:73], v111 offset:2080
    ds_read_b64_tr_b16 a[74:75], v111 offset:2336
    s_waitcnt lgkmcnt(10)
    v_mfma_f32_32x32x16_bf16 v[16:31], v[80:83], a[64:67], v[16:31]
    ds_read_b64_tr_b16 a[68:69], v111 offset:1040
    ds_read_b64_tr_b16 a[70:71], v111 offset:1296
    s_waitcnt lgkmcnt(8)
    v_mfma_f32_16x16x32_bf16 v[0:3], v[96:99], v[100:103], v[0:3]
    v_mfma_f32_32x32x16_bf16 v[48:63], v[84:87], a[64:67], v[48:63]
    ds_read_b64_tr_b16 v[100:101], v109 offset:1040
    ds_read_b64_tr_b16 v[102:103], v109 offset:1296
    ds_read_b64_tr_b16 a[76:77], v111 offset:3120
    ds_read_b64_tr_b16 a[78:79], v111 offset:3376
    s_waitcnt lgkmcnt(9)
    v_mfma_f32_16x16x32_bf16 v[4:7], v[96:99], v[104:107], v[4:7]
    ds_read_b64_tr_b16 v[104:105], v109 offset:1072
    ds_read_b64_tr_b16 v[106:107], v109 offset:1328
    s_waitcnt lgkmcnt(8)
    v_mfma_f32_32x32x16_bf16 v[16:31], v[88:91], a[72:75], v[16:31]
    v_mfma_f32_32x32x16_bf16 v[48:63], v[92:95], a[72:75], v[48:63]
    s_waitcnt lgkmcnt(6)
    v_mfma_f32_32x32x16_bf16 v[32:47], v[80:83], a[68:71], v[32:47]
    s_waitcnt lgkmcnt(0)
    s_barrier
    ds_read_b128 v[80:83], v118 offset:17152
    ds_read_b64_tr_b16 a[80:81], v111 offset:4160
    ds_read_b64_tr_b16 a[82:83], v111 offset:4416
    v_mfma_f32_16x16x32_bf16 v[8:11], v[96:99], v[100:103], v[8:11]
    v_mfma_f32_32x32x16_bf16 v[64:79], v[84:87], a[68:71], v[64:79]
    ds_read_b128 v[84:87], v118 offset:33792
    ds_read_b64_tr_b16 v[100:101], v109 offset:4160
    ds_read_b64_tr_b16 v[102:103], v109 offset:4416
    v_mfma_f32_16x16x32_bf16 v[12:15], v[96:99], v[104:107], v[12:15]
    ds_read_b128 v[96:99], v108 offset:4672
    v_mfma_f32_32x32x16_bf16 v[32:47], v[88:91], a[76:79], v[32:47]
    ds_read_b128 v[88:91], v118 offset:17184
    ds_read_b64_tr_b16 v[104:105], v109 offset:4192
    ds_read_b64_tr_b16 v[106:107], v109 offset:4448
    v_mfma_f32_32x32x16_bf16 v[64:79], v[92:95], a[76:79], v[64:79]
    ds_read_b128 v[92:95], v118 offset:33824
    ds_read_b64_tr_b16 a[88:89], v111 offset:6240
    ds_read_b64_tr_b16 a[90:91], v111 offset:6496
    s_waitcnt lgkmcnt(10)
    v_mfma_f32_32x32x16_bf16 v[16:31], v[80:83], a[80:83], v[16:31]
    ds_read_b64_tr_b16 a[84:85], v111 offset:5200
    ds_read_b64_tr_b16 a[86:87], v111 offset:5456
    s_waitcnt lgkmcnt(8)
    v_mfma_f32_16x16x32_bf16 v[0:3], v[96:99], v[100:103], v[0:3]
    v_mfma_f32_32x32x16_bf16 v[48:63], v[84:87], a[80:83], v[48:63]
    ds_read_b64_tr_b16 v[100:101], v109 offset:5200
    ds_read_b64_tr_b16 v[102:103], v109 offset:5456
    ds_read_b64_tr_b16 a[92:93], v111 offset:7280
    ds_read_b64_tr_b16 a[94:95], v111 offset:7536
    s_waitcnt lgkmcnt(9)
    v_mfma_f32_16x16x32_bf16 v[4:7], v[96:99], v[104:107], v[4:7]
    ds_read_b64_tr_b16 v[104:105], v109 offset:5232
    ds_read_b64_tr_b16 v[106:107], v109 offset:5488
    s_waitcnt lgkmcnt(8)
    v_mfma_f32_32x32x16_bf16 v[16:31], v[88:91], a[88:91], v[16:31]
    v_mfma_f32_32x32x16_bf16 v[48:63], v[92:95], a[88:91], v[48:63]
    s_waitcnt lgkmcnt(6)
    v_mfma_f32_32x32x16_bf16 v[32:47], v[80:83], a[84:87], v[32:47]
    s_waitcnt lgkmcnt(0)
    s_barrier
    v_subrev_u32 v111, s94, v111
    v_subrev_u32 v109, s94, v109
    ds_read_b128 v[80:83], v118 offset:20800
    ds_read_b64_tr_b16 a[96:97], v111
    ds_read_b64_tr_b16 a[98:99], v111 offset:256
    v_mfma_f32_16x16x32_bf16 v[8:11], v[96:99], v[100:103], v[8:11]
    v_mfma_f32_32x32x16_bf16 v[64:79], v[84:87], a[84:87], v[64:79]
    ds_read_b128 v[84:87], v118 offset:37440
    ds_read_b64_tr_b16 v[100:101], v109
    ds_read_b64_tr_b16 v[102:103], v109 offset:256
    v_mfma_f32_16x16x32_bf16 v[12:15], v[96:99], v[104:107], v[12:15]
    ds_read_b128 v[96:99], v108 offset:6240
    v_mfma_f32_32x32x16_bf16 v[32:47], v[88:91], a[92:95], v[32:47]
    ds_read_b128 v[88:91], v118 offset:20832
    ds_read_b64_tr_b16 v[104:105], v109 offset:32
    ds_read_b64_tr_b16 v[106:107], v109 offset:288
    v_mfma_f32_32x32x16_bf16 v[64:79], v[92:95], a[92:95], v[64:79]
    ds_read_b128 v[92:95], v118 offset:37472
    ds_read_b64_tr_b16 a[104:105], v111 offset:2080
    ds_read_b64_tr_b16 a[106:107], v111 offset:2336
    s_waitcnt lgkmcnt(10)
    v_mfma_f32_32x32x16_bf16 v[16:31], v[80:83], a[96:99], v[16:31]
    ds_read_b64_tr_b16 a[100:101], v111 offset:1040
    ds_read_b64_tr_b16 a[102:103], v111 offset:1296
    s_waitcnt lgkmcnt(8)
    v_mfma_f32_16x16x32_bf16 v[0:3], v[96:99], v[100:103], v[0:3]
    v_mfma_f32_32x32x16_bf16 v[48:63], v[84:87], a[96:99], v[48:63]
    ds_read_b64_tr_b16 v[100:101], v109 offset:1040
    ds_read_b64_tr_b16 v[102:103], v109 offset:1296
    ds_read_b64_tr_b16 a[108:109], v111 offset:3120
    ds_read_b64_tr_b16 a[110:111], v111 offset:3376
    s_waitcnt lgkmcnt(9)
    v_mfma_f32_16x16x32_bf16 v[4:7], v[96:99], v[104:107], v[4:7]
    ds_read_b64_tr_b16 v[104:105], v109 offset:1072
    ds_read_b64_tr_b16 v[106:107], v109 offset:1328
    s_waitcnt lgkmcnt(8)
    v_mfma_f32_32x32x16_bf16 v[16:31], v[88:91], a[104:107], v[16:31]
    v_mfma_f32_32x32x16_bf16 v[48:63], v[92:95], a[104:107], v[48:63]
    s_waitcnt lgkmcnt(6)
    v_mfma_f32_32x32x16_bf16 v[32:47], v[80:83], a[100:103], v[32:47]
    s_waitcnt lgkmcnt(0)
    s_barrier
    ds_read_b128 v[80:83], v118 offset:21312
    ds_read_b64_tr_b16 a[112:113], v111 offset:4160
    ds_read_b64_tr_b16 a[114:115], v111 offset:4416
    v_mfma_f32_16x16x32_bf16 v[8:11], v[96:99], v[100:103], v[8:11]
    v_mfma_f32_32x32x16_bf16 v[64:79], v[84:87], a[100:103], v[64:79]
    ds_read_b128 v[84:87], v118 offset:37952
    ds_read_b64_tr_b16 v[100:101], v109 offset:4160
    ds_read_b64_tr_b16 v[102:103], v109 offset:4416
    v_mfma_f32_16x16x32_bf16 v[12:15], v[96:99], v[104:107], v[12:15]
    ds_read_b128 v[96:99], v108 offset:6752
    v_mfma_f32_32x32x16_bf16 v[32:47], v[88:91], a[108:111], v[32:47]
    ds_read_b128 v[88:91], v118 offset:21344
    ds_read_b64_tr_b16 v[104:105], v109 offset:4192
    ds_read_b64_tr_b16 v[106:107], v109 offset:4448
    v_mfma_f32_32x32x16_bf16 v[64:79], v[92:95], a[108:111], v[64:79]
    ds_read_b128 v[92:95], v118 offset:37984
    ds_read_b64_tr_b16 a[120:121], v111 offset:6240
    ds_read_b64_tr_b16 a[122:123], v111 offset:6496
    s_waitcnt lgkmcnt(10)
    v_mfma_f32_32x32x16_bf16 v[16:31], v[80:83], a[112:115], v[16:31]
    ds_read_b64_tr_b16 a[116:117], v111 offset:5200
    ds_read_b64_tr_b16 a[118:119], v111 offset:5456
    s_waitcnt lgkmcnt(8)
    v_mfma_f32_16x16x32_bf16 v[0:3], v[96:99], v[100:103], v[0:3]
    v_mfma_f32_32x32x16_bf16 v[48:63], v[84:87], a[112:115], v[48:63]
    ds_read_b64_tr_b16 v[100:101], v109 offset:5200
    ds_read_b64_tr_b16 v[102:103], v109 offset:5456
    ds_read_b64_tr_b16 a[124:125], v111 offset:7280
    ds_read_b64_tr_b16 a[126:127], v111 offset:7536
    s_waitcnt lgkmcnt(9)
    v_mfma_f32_16x16x32_bf16 v[4:7], v[96:99], v[104:107], v[4:7]
    ds_read_b64_tr_b16 v[104:105], v109 offset:5232
    ds_read_b64_tr_b16 v[106:107], v109 offset:5488
    s_waitcnt lgkmcnt(8)
    v_mfma_f32_32x32x16_bf16 v[16:31], v[88:91], a[120:123], v[16:31]
    v_mfma_f32_32x32x16_bf16 v[48:63], v[92:95], a[120:123], v[48:63]
    s_waitcnt lgkmcnt(6)
    v_mfma_f32_32x32x16_bf16 v[32:47], v[80:83], a[116:119], v[32:47]
    s_waitcnt lgkmcnt(2)
    v_mfma_f32_16x16x32_bf16 v[8:11], v[96:99], v[100:103], v[8:11]
    v_mfma_f32_32x32x16_bf16 v[64:79], v[84:87], a[116:119], v[64:79]
    s_waitcnt lgkmcnt(0)
    v_mfma_f32_16x16x32_bf16 v[12:15], v[96:99], v[104:107], v[12:15]
    v_mfma_f32_32x32x16_bf16 v[32:47], v[88:91], a[124:127], v[32:47]
    v_mfma_f32_32x32x16_bf16 v[64:79], v[92:95], a[124:127], v[64:79]
    s_setprio 0
    v_and_b32 v95, -4, v112
    v_and_b32 v93, 2, v112
    v_mov_b32 v94, v113
    v_mov_b32 v106, v114
    v_mov_b32 v107, v115
    v_mul_f32 v8, s32, v8
    v_mul_f32 v9, s32, v9
    v_mul_f32 v10, s32, v10
    v_mul_f32 v11, s32, v11
    v_exp_f32 v8, v8
    s_setprio 3
    ds_read2_b32 v[108:109], v95 offset0:0 offset1:1
    ds_read2_b32 v[110:111], v95 offset0:2 offset1:3
    ds_read2_b32 v[112:113], v95 offset0:4 offset1:5
    ds_read2_b32 v[114:115], v95 offset0:6 offset1:7
    s_setprio 0
    v_exp_f32 v9, v9
    s_setprio 3
    s_waitcnt vmcnt(0)
    ds_read2_b32 v[116:117], v95 offset0:8 offset1:9
    ds_read2_b32 v[96:97], v95 offset0:160 offset1:161
    ds_read2_b32 v[98:99], v95 offset0:162 offset1:163
    ds_read2_b32 v[100:101], v95 offset0:164 offset1:165
    s_setprio 0
    v_exp_f32 v10, v10
    s_setprio 3
    ds_read2_b32 v[102:103], v95 offset0:166 offset1:167
    ds_read2_b32 v[104:105], v95 offset0:168 offset1:169
    ds_read_b32 v91, v95 offset:40
    ds_read_b32 v92, v95 offset:680
    s_setprio 0
    v_exp_f32 v11, v11
    v_fma_f32 v8, v8, s33, s33
    v_fma_f32 v9, v9, s33, s33
    v_fma_f32 v10, v10, s33, s33
    v_fma_f32 v11, v11, s33, s33
    v_rcp_f32 v8, v8
    v_rcp_f32 v9, v9
    v_rcp_f32 v10, v10
    v_rcp_f32 v11, v11
    v_mul_f32 v0, v0, v8
    v_mul_f32 v1, v1, v9
    v_mul_f32 v2, v2, v10
    v_mul_f32 v3, v3, v11
    v_cvt_pk_bf16_f32 v8, v0, v1
    v_cvt_pk_bf16_f32 v9, v2, v3
    s_setprio 3
    ds_write_b64 v94, v[8:9]
    s_setprio 0
    v_mul_f32 v12, s32, v12
    v_mul_f32 v13, s32, v13
    v_mul_f32 v14, s32, v14
    v_mul_f32 v15, s32, v15
    v_exp_f32 v12, v12
    v_exp_f32 v13, v13
    v_exp_f32 v14, v14
    v_exp_f32 v15, v15
    v_fma_f32 v12, v12, s33, s33
    v_fma_f32 v13, v13, s33, s33
    v_fma_f32 v14, v14, s33, s33
    v_fma_f32 v15, v15, s33, s33
    v_rcp_f32 v12, v12
    v_rcp_f32 v13, v13
    v_rcp_f32 v14, v14
    v_rcp_f32 v15, v15
    v_mul_f32 v4, v4, v12
    v_mul_f32 v5, v5, v13
    v_mul_f32 v6, v6, v14
    v_mul_f32 v7, v7, v15
    v_cvt_pk_bf16_f32 v10, v4, v5
    v_cvt_pk_bf16_f32 v11, v6, v7
    s_setprio 3
    ds_write_b64 v94, v[10:11] offset:2816
    s_setprio 0
    v_mul_f32 v32, s32, v32
    v_mul_f32 v33, s32, v33
    v_mul_f32 v34, s32, v34
    v_mul_f32 v35, s32, v35
    v_exp_f32 v32, v32
    v_exp_f32 v33, v33
    v_exp_f32 v34, v34
    v_exp_f32 v35, v35
    v_fma_f32 v32, v32, s33, s33
    v_fma_f32 v33, v33, s33, s33
    v_fma_f32 v34, v34, s33, s33
    v_fma_f32 v35, v35, s33, s33
    v_rcp_f32 v32, v32
    v_rcp_f32 v33, v33
    v_rcp_f32 v34, v34
    v_rcp_f32 v35, v35
    v_mul_f32 v16, v16, v32
    v_mul_f32 v17, v17, v33
    v_mul_f32 v18, v18, v34
    v_mul_f32 v19, v19, v35
    v_cvt_pk_bf16_f32 v32, v16, v17
    v_cvt_pk_bf16_f32 v33, v18, v19
    v_mul_f32 v36, s32, v36
    v_mul_f32 v37, s32, v37
    v_mul_f32 v38, s32, v38
    v_mul_f32 v39, s32, v39
    v_exp_f32 v36, v36
    v_exp_f32 v37, v37
    v_exp_f32 v38, v38
    v_exp_f32 v39, v39
    v_fma_f32 v36, v36, s33, s33
    v_fma_f32 v37, v37, s33, s33
    v_fma_f32 v38, v38, s33, s33
    v_fma_f32 v39, v39, s33, s33
    v_rcp_f32 v36, v36
    v_rcp_f32 v37, v37
    v_rcp_f32 v38, v38
    v_rcp_f32 v39, v39
    v_mul_f32 v20, v20, v36
    v_mul_f32 v21, v21, v37
    v_mul_f32 v22, v22, v38
    v_mul_f32 v23, v23, v39
    v_cvt_pk_bf16_f32 v34, v20, v21
    v_cvt_pk_bf16_f32 v35, v22, v23
    s_setprio 3
    ds_write_b128 v119, v[32:35] offset:32
    s_setprio 0
    v_mul_f32 v40, s32, v40
    v_mul_f32 v41, s32, v41
    v_mul_f32 v42, s32, v42
    v_mul_f32 v43, s32, v43
    v_exp_f32 v40, v40
    v_exp_f32 v41, v41
    v_exp_f32 v42, v42
    v_exp_f32 v43, v43
    v_fma_f32 v40, v40, s33, s33
    v_fma_f32 v41, v41, s33, s33
    v_fma_f32 v42, v42, s33, s33
    v_fma_f32 v43, v43, s33, s33
    v_rcp_f32 v40, v40
    v_rcp_f32 v41, v41
    v_rcp_f32 v42, v42
    v_rcp_f32 v43, v43
    v_mul_f32 v24, v24, v40
    v_mul_f32 v25, v25, v41
    v_mul_f32 v26, v26, v42
    v_mul_f32 v27, v27, v43
    v_cvt_pk_bf16_f32 v36, v24, v25
    v_cvt_pk_bf16_f32 v37, v26, v27
    v_mul_f32 v44, s32, v44
    v_mul_f32 v45, s32, v45
    v_mul_f32 v46, s32, v46
    v_mul_f32 v47, s32, v47
    v_exp_f32 v44, v44
    v_exp_f32 v45, v45
    v_exp_f32 v46, v46
    v_exp_f32 v47, v47
    v_fma_f32 v44, v44, s33, s33
    v_fma_f32 v45, v45, s33, s33
    v_fma_f32 v46, v46, s33, s33
    v_fma_f32 v47, v47, s33, s33
    v_rcp_f32 v44, v44
    v_rcp_f32 v45, v45
    v_rcp_f32 v46, v46
    v_rcp_f32 v47, v47
    v_mul_f32 v28, v28, v44
    v_mul_f32 v29, v29, v45
    v_mul_f32 v30, v30, v46
    v_mul_f32 v31, v31, v47
    v_cvt_pk_bf16_f32 v38, v28, v29
    v_cvt_pk_bf16_f32 v39, v30, v31
    s_setprio 3
    ds_write_b128 v119, v[36:39] offset:48
    ds_read_b128 v[16:19], v120 offset:32
    ds_read_b128 v[28:31], v120 offset:2848
    ds_read_b128 v[20:23], v120 offset:48
    ds_read_b128 v[40:43], v120 offset:2864
    ds_read_b128 v[24:27], v120 offset:64
    ds_read_b128 v[44:47], v120 offset:2880
    s_setprio 0
    v_mul_f32 v64, s32, v64
    v_mul_f32 v65, s32, v65
    v_mul_f32 v66, s32, v66
    v_mul_f32 v67, s32, v67
    v_exp_f32 v64, v64
    v_exp_f32 v65, v65
    v_exp_f32 v66, v66
    v_exp_f32 v67, v67
    v_fma_f32 v64, v64, s33, s33
    v_fma_f32 v65, v65, s33, s33
    v_fma_f32 v66, v66, s33, s33
    v_fma_f32 v67, v67, s33, s33
    v_rcp_f32 v64, v64
    v_rcp_f32 v65, v65
    v_rcp_f32 v66, v66
    v_rcp_f32 v67, v67
    v_mul_f32 v48, v48, v64
    v_mul_f32 v49, v49, v65
    v_mul_f32 v50, v50, v66
    v_mul_f32 v51, v51, v67
    v_cvt_pk_bf16_f32 v64, v48, v49
    v_cvt_pk_bf16_f32 v65, v50, v51
    v_mul_f32 v68, s32, v68
    v_mul_f32 v69, s32, v69
    v_mul_f32 v70, s32, v70
    v_mul_f32 v71, s32, v71
    v_exp_f32 v68, v68
    v_exp_f32 v69, v69
    v_exp_f32 v70, v70
    v_exp_f32 v71, v71
    v_fma_f32 v68, v68, s33, s33
    v_fma_f32 v69, v69, s33, s33
    v_fma_f32 v70, v70, s33, s33
    v_fma_f32 v71, v71, s33, s33
    v_rcp_f32 v68, v68
    v_rcp_f32 v69, v69
    v_rcp_f32 v70, v70
    v_rcp_f32 v71, v71
    v_mul_f32 v52, v52, v68
    v_mul_f32 v53, v53, v69
    v_mul_f32 v54, v54, v70
    v_mul_f32 v55, v55, v71
    v_cvt_pk_bf16_f32 v66, v52, v53
    v_cvt_pk_bf16_f32 v67, v54, v55
    s_setprio 3
    ds_write_b128 v119, v[64:67] offset:96
    s_setprio 0
    v_mul_f32 v72, s32, v72
    v_mul_f32 v73, s32, v73
    v_mul_f32 v74, s32, v74
    v_mul_f32 v75, s32, v75
    v_exp_f32 v72, v72
    v_exp_f32 v73, v73
    v_exp_f32 v74, v74
    v_exp_f32 v75, v75
    v_fma_f32 v72, v72, s33, s33
    v_fma_f32 v73, v73, s33, s33
    v_fma_f32 v74, v74, s33, s33
    v_fma_f32 v75, v75, s33, s33
    v_rcp_f32 v72, v72
    v_rcp_f32 v73, v73
    v_rcp_f32 v74, v74
    v_rcp_f32 v75, v75
    v_mul_f32 v56, v56, v72
    v_mul_f32 v57, v57, v73
    v_mul_f32 v58, v58, v74
    v_mul_f32 v59, v59, v75
    v_cvt_pk_bf16_f32 v68, v56, v57
    v_cvt_pk_bf16_f32 v69, v58, v59
    v_mul_f32 v76, s32, v76
    v_mul_f32 v77, s32, v77
    v_mul_f32 v78, s32, v78
    v_mul_f32 v79, s32, v79
    v_exp_f32 v76, v76
    v_exp_f32 v77, v77
    v_exp_f32 v78, v78
    v_exp_f32 v79, v79
    v_fma_f32 v76, v76, s33, s33
    v_fma_f32 v77, v77, s33, s33
    v_fma_f32 v78, v78, s33, s33
    v_fma_f32 v79, v79, s33, s33
    v_rcp_f32 v76, v76
    v_rcp_f32 v77, v77
    v_rcp_f32 v78, v78
    v_rcp_f32 v79, v79
    v_mul_f32 v60, v60, v76
    v_mul_f32 v61, v61, v77
    v_mul_f32 v62, v62, v78
    v_mul_f32 v63, v63, v79
    v_cvt_pk_bf16_f32 v70, v60, v61
    v_cvt_pk_bf16_f32 v71, v62, v63
    ds_write_b128 v119, v[68:71] offset:112
    s_waitcnt lgkmcnt(1)
    v_alignbyte_b32 v108, v109, v108, v93
    v_alignbyte_b32 v109, v110, v109, v93
    v_alignbyte_b32 v110, v111, v110, v93
    v_alignbyte_b32 v111, v112, v111, v93
    v_alignbyte_b32 v112, v113, v112, v93
    v_alignbyte_b32 v113, v114, v113, v93
    v_alignbyte_b32 v114, v115, v114, v93
    v_alignbyte_b32 v115, v116, v115, v93
    v_alignbyte_b32 v116, v117, v116, v93
    v_alignbyte_b32 v117, v91, v117, v93
    v_alignbyte_b32 v96, v97, v96, v93
    v_alignbyte_b32 v97, v98, v97, v93
    v_alignbyte_b32 v98, v99, v98, v93
    v_alignbyte_b32 v99, v100, v99, v93
    v_alignbyte_b32 v100, v101, v100, v93
    v_alignbyte_b32 v101, v102, v101, v93
    v_alignbyte_b32 v102, v103, v102, v93
    v_alignbyte_b32 v103, v104, v103, v93
    v_alignbyte_b32 v104, v105, v104, v93
    v_alignbyte_b32 v105, v92, v105, v93
    s_setprio 3
    v_mfma_f32_4x4x4_16b_bf16 v[0:3], v[108:109], v[16:17], 0
    v_mfma_f32_4x4x4_16b_bf16 v[4:7], v[108:109], v[18:19], 0
    v_mfma_f32_4x4x4_16b_bf16 v[8:11], v[96:97], v[28:29], 0
    v_mfma_f32_4x4x4_16b_bf16 v[12:15], v[96:97], v[30:31], 0
    v_mfma_f32_4x4x4_16b_bf16 v[0:3], v[110:111], v[18:19], v[0:3]
    v_mfma_f32_4x4x4_16b_bf16 v[4:7], v[110:111], v[20:21], v[4:7]
    v_mfma_f32_4x4x4_16b_bf16 v[8:11], v[98:99], v[30:31], v[8:11]
    v_mfma_f32_4x4x4_16b_bf16 v[12:15], v[98:99], v[40:41], v[12:15]
    v_mfma_f32_4x4x4_16b_bf16 v[0:3], v[112:113], v[20:21], v[0:3]
    v_mfma_f32_4x4x4_16b_bf16 v[4:7], v[112:113], v[22:23], v[4:7]
    v_mfma_f32_4x4x4_16b_bf16 v[8:11], v[100:101], v[40:41], v[8:11]
    v_mfma_f32_4x4x4_16b_bf16 v[12:15], v[100:101], v[42:43], v[12:15]
    v_mfma_f32_4x4x4_16b_bf16 v[0:3], v[114:115], v[22:23], v[0:3]
    v_mfma_f32_4x4x4_16b_bf16 v[4:7], v[114:115], v[24:25], v[4:7]
    v_mfma_f32_4x4x4_16b_bf16 v[8:11], v[102:103], v[42:43], v[8:11]
    v_mfma_f32_4x4x4_16b_bf16 v[12:15], v[102:103], v[44:45], v[12:15]
    v_mfma_f32_4x4x4_16b_bf16 v[0:3], v[116:117], v[24:25], v[0:3]
    v_mfma_f32_4x4x4_16b_bf16 v[4:7], v[116:117], v[26:27], v[4:7]
    v_mfma_f32_4x4x4_16b_bf16 v[8:11], v[104:105], v[44:45], v[8:11]
    v_mfma_f32_4x4x4_16b_bf16 v[12:15], v[104:105], v[46:47], v[12:15]
    s_setprio 0
    ds_read_b128 v[16:19], v120 offset:96
    ds_read_b128 v[28:31], v120 offset:2912
    ds_read_b128 v[20:23], v120 offset:112
    ds_read_b128 v[40:43], v120 offset:2928
    ds_read_b128 v[24:27], v120 offset:128
    ds_read_b128 v[44:47], v120 offset:2944
    v_exp_f32 v32, v0
    v_exp_f32 v33, v1
    v_exp_f32 v34, v2
    v_exp_f32 v35, v3
    v_fma_f32 v32, v32, s32, s32
    v_fma_f32 v33, v33, s32, s32
    v_fma_f32 v34, v34, s32, s32
    v_fma_f32 v35, v35, s32, s32
    v_rcp_f32 v32, v32
    v_rcp_f32 v33, v33
    v_rcp_f32 v34, v34
    v_rcp_f32 v35, v35
    v_mul_f32 v0, v0, v32
    v_mul_f32 v1, v1, v33
    v_mul_f32 v2, v2, v34
    v_mul_f32 v3, v3, v35
    v_cvt_pk_bf16_f32 v0, v0, v1
    v_cvt_pk_bf16_f32 v1, v2, v3
    v_exp_f32 v36, v4
    v_exp_f32 v37, v5
    v_exp_f32 v38, v6
    v_exp_f32 v39, v7
    v_fma_f32 v36, v36, s32, s32
    v_fma_f32 v37, v37, s32, s32
    v_fma_f32 v38, v38, s32, s32
    v_fma_f32 v39, v39, s32, s32
    v_rcp_f32 v36, v36
    v_rcp_f32 v37, v37
    v_rcp_f32 v38, v38
    v_rcp_f32 v39, v39
    v_mul_f32 v4, v4, v36
    v_mul_f32 v5, v5, v37
    v_mul_f32 v6, v6, v38
    v_mul_f32 v7, v7, v39
    v_cvt_pk_bf16_f32 v2, v4, v5
    v_cvt_pk_bf16_f32 v3, v6, v7
    ds_write_b128 v121, v[0:3]
    v_exp_f32 v32, v8
    v_exp_f32 v33, v9
    v_exp_f32 v34, v10
    v_exp_f32 v35, v11
    v_fma_f32 v32, v32, s32, s32
    v_fma_f32 v33, v33, s32, s32
    v_fma_f32 v34, v34, s32, s32
    v_fma_f32 v35, v35, s32, s32
    v_rcp_f32 v32, v32
    v_rcp_f32 v33, v33
    v_rcp_f32 v34, v34
    v_rcp_f32 v35, v35
    v_mul_f32 v8, v8, v32
    v_mul_f32 v9, v9, v33
    v_mul_f32 v10, v10, v34
    v_mul_f32 v11, v11, v35
    v_cvt_pk_bf16_f32 v8, v8, v9
    v_cvt_pk_bf16_f32 v9, v10, v11
    v_exp_f32 v36, v12
    v_exp_f32 v37, v13
    v_exp_f32 v38, v14
    v_exp_f32 v39, v15
    v_fma_f32 v36, v36, s32, s32
    v_fma_f32 v37, v37, s32, s32
    v_fma_f32 v38, v38, s32, s32
    v_fma_f32 v39, v39, s32, s32
    v_rcp_f32 v36, v36
    v_rcp_f32 v37, v37
    v_rcp_f32 v38, v38
    v_rcp_f32 v39, v39
    v_mul_f32 v12, v12, v36
    v_mul_f32 v13, v13, v37
    v_mul_f32 v14, v14, v38
    v_mul_f32 v15, v15, v39
    v_cvt_pk_bf16_f32 v10, v12, v13
    v_cvt_pk_bf16_f32 v11, v14, v15
    ds_write_b128 v121, v[8:11] offset:1024
    s_setprio 3
    s_waitcnt lgkmcnt(1)
    v_mfma_f32_4x4x4_16b_bf16 v[0:3], v[108:109], v[16:17], 0
    v_mfma_f32_4x4x4_16b_bf16 v[4:7], v[108:109], v[18:19], 0
    v_mfma_f32_4x4x4_16b_bf16 v[8:11], v[96:97], v[28:29], 0
    v_mfma_f32_4x4x4_16b_bf16 v[12:15], v[96:97], v[30:31], 0
    v_mfma_f32_4x4x4_16b_bf16 v[0:3], v[110:111], v[18:19], v[0:3]
    v_mfma_f32_4x4x4_16b_bf16 v[4:7], v[110:111], v[20:21], v[4:7]
    v_mfma_f32_4x4x4_16b_bf16 v[8:11], v[98:99], v[30:31], v[8:11]
    v_mfma_f32_4x4x4_16b_bf16 v[12:15], v[98:99], v[40:41], v[12:15]
    v_mfma_f32_4x4x4_16b_bf16 v[0:3], v[112:113], v[20:21], v[0:3]
    v_mfma_f32_4x4x4_16b_bf16 v[4:7], v[112:113], v[22:23], v[4:7]
    v_mfma_f32_4x4x4_16b_bf16 v[8:11], v[100:101], v[40:41], v[8:11]
    v_mfma_f32_4x4x4_16b_bf16 v[12:15], v[100:101], v[42:43], v[12:15]
    v_mfma_f32_4x4x4_16b_bf16 v[0:3], v[114:115], v[22:23], v[0:3]
    v_mfma_f32_4x4x4_16b_bf16 v[4:7], v[114:115], v[24:25], v[4:7]
    v_mfma_f32_4x4x4_16b_bf16 v[8:11], v[102:103], v[42:43], v[8:11]
    v_mfma_f32_4x4x4_16b_bf16 v[12:15], v[102:103], v[44:45], v[12:15]
    v_mfma_f32_4x4x4_16b_bf16 v[0:3], v[116:117], v[24:25], v[0:3]
    v_mfma_f32_4x4x4_16b_bf16 v[4:7], v[116:117], v[26:27], v[4:7]
    v_mfma_f32_4x4x4_16b_bf16 v[8:11], v[104:105], v[44:45], v[8:11]
    v_mfma_f32_4x4x4_16b_bf16 v[12:15], v[104:105], v[46:47], v[12:15]
    s_setprio 0
    ds_write_b128 v120, v[24:27]
    ds_write_b128 v120, v[44:47] offset:2816
    v_exp_f32 v32, v0
    v_exp_f32 v33, v1
    v_exp_f32 v34, v2
    v_exp_f32 v35, v3
    v_fma_f32 v32, v32, s32, s32
    v_fma_f32 v33, v33, s32, s32
    v_fma_f32 v34, v34, s32, s32
    v_fma_f32 v35, v35, s32, s32
    v_rcp_f32 v32, v32
    v_rcp_f32 v33, v33
    v_rcp_f32 v34, v34
    v_rcp_f32 v35, v35
    v_mul_f32 v0, v0, v32
    v_mul_f32 v1, v1, v33
    v_mul_f32 v2, v2, v34
    v_mul_f32 v3, v3, v35
    v_cvt_pk_bf16_f32 v0, v0, v1
    v_cvt_pk_bf16_f32 v1, v2, v3
    v_exp_f32 v36, v4
    v_exp_f32 v37, v5
    v_exp_f32 v38, v6
    v_exp_f32 v39, v7
    v_fma_f32 v36, v36, s32, s32
    v_fma_f32 v37, v37, s32, s32
    v_fma_f32 v38, v38, s32, s32
    v_fma_f32 v39, v39, s32, s32
    v_rcp_f32 v36, v36
    v_rcp_f32 v37, v37
    v_rcp_f32 v38, v38
    v_rcp_f32 v39, v39
    v_mul_f32 v4, v4, v36
    v_mul_f32 v5, v5, v37
    v_mul_f32 v6, v6, v38
    v_mul_f32 v7, v7, v39
    v_cvt_pk_bf16_f32 v2, v4, v5
    v_cvt_pk_bf16_f32 v3, v6, v7
    ds_write_b128 v121, v[0:3] offset:2048
    v_exp_f32 v32, v8
    v_exp_f32 v33, v9
    v_exp_f32 v34, v10
    v_exp_f32 v35, v11
    v_fma_f32 v32, v32, s32, s32
    v_fma_f32 v33, v33, s32, s32
    v_fma_f32 v34, v34, s32, s32
    v_fma_f32 v35, v35, s32, s32
    v_rcp_f32 v32, v32
    v_rcp_f32 v33, v33
    v_rcp_f32 v34, v34
    v_rcp_f32 v35, v35
    v_mul_f32 v8, v8, v32
    v_mul_f32 v9, v9, v33
    v_mul_f32 v10, v10, v34
    v_mul_f32 v11, v11, v35
    v_cvt_pk_bf16_f32 v8, v8, v9
    v_cvt_pk_bf16_f32 v9, v10, v11
    v_exp_f32 v36, v12
    v_exp_f32 v37, v13
    v_exp_f32 v38, v14
    v_exp_f32 v39, v15
    v_fma_f32 v36, v36, s32, s32
    v_fma_f32 v37, v37, s32, s32
    v_fma_f32 v38, v38, s32, s32
    v_fma_f32 v39, v39, s32, s32
    v_rcp_f32 v36, v36
    v_rcp_f32 v37, v37
    v_rcp_f32 v38, v38
    v_rcp_f32 v39, v39
    v_mul_f32 v12, v12, v36
    v_mul_f32 v13, v13, v37
    v_mul_f32 v14, v14, v38
    v_mul_f32 v15, v15, v39
    v_cvt_pk_bf16_f32 v10, v12, v13
    v_cvt_pk_bf16_f32 v11, v14, v15
    ds_write_b128 v121, v[8:11] offset:3072
    v_add_u32 v118, 0xa280, v118
    s_barrier
    s_setprio 2
    ds_read_b128 v[80:83], v118
    ds_read_b128 v[84:87], v118 offset:16640
    s_waitcnt lgkmcnt(1)
    v_mfma_f32_32x32x16_bf16 v[16:31], v[80:83], a[0:3], 0
    ds_read_b128 v[88:91], v118 offset:32
    s_mov_b32 m0, s34
    s_nop 0
    buffer_load_dwordx4 v122, s[12:15], 0 offen lds
    v_mfma_f32_32x32x16_bf16 v[32:47], v[80:83], a[4:7], 0
    s_add_u32 m0, s34, 0x410
    s_nop 0
    buffer_load_dwordx4 v122, s[12:15], 64 offen lds
    s_waitcnt lgkmcnt(1)
    v_mfma_f32_32x32x16_bf16 v[64:79], v[84:87], a[4:7], 0
    ds_read_b128 v[92:95], v118 offset:16672
    s_add_u32 m0, s34, 0x820
    s_mov_b32 s30, 0x2000
    buffer_load_dwordx4 v122, s[12:15], s30 offen lds
    v_mfma_f32_32x32x16_bf16 v[48:63], v[84:87], a[0:3], 0
    s_add_u32 m0, s34, 0xc30
    s_mov_b32 s30, 0x2040
    buffer_load_dwordx4 v122, s[12:15], s30 offen lds
    s_waitcnt lgkmcnt(1)
    v_mfma_f32_32x32x16_bf16 v[16:31], v[88:91], a[8:11], v[16:31]
    ds_read_b128 v[80:83], v118 offset:512
    s_add_u32 m0, s34, 0x1040
    s_mov_b32 s30, 0x4000
    buffer_load_dwordx4 v122, s[12:15], s30 offen lds
    v_mfma_f32_32x32x16_bf16 v[32:47], v[88:91], a[12:15], v[32:47]
    s_add_u32 m0, s34, 0x1450
    s_mov_b32 s30, 0x4040
    buffer_load_dwordx4 v122, s[12:15], s30 offen lds
    s_waitcnt lgkmcnt(1)
    v_mfma_f32_32x32x16_bf16 v[64:79], v[92:95], a[12:15], v[64:79]
    ds_read_b128 v[84:87], v118 offset:17152
    s_add_u32 m0, s34, 0x1860
    s_mov_b32 s30, 0x6000
    buffer_load_dwordx4 v122, s[12:15], s30 offen lds
    v_mfma_f32_32x32x16_bf16 v[48:63], v[92:95], a[8:11], v[48:63]
    s_add_u32 m0, s34, 0x1c70
    s_mov_b32 s30, 0x6040
    buffer_load_dwordx4 v122, s[12:15], s30 offen lds
    s_waitcnt lgkmcnt(1)
    v_mfma_f32_32x32x16_bf16 v[16:31], v[80:83], a[16:19], v[16:31]
    ds_read_b128 v[88:91], v118 offset:544
    v_mfma_f32_32x32x16_bf16 v[32:47], v[80:83], a[20:23], v[32:47]
    s_waitcnt lgkmcnt(1)
    v_mfma_f32_32x32x16_bf16 v[64:79], v[84:87], a[20:23], v[64:79]
    ds_read_b128 v[92:95], v118 offset:17184
    v_mfma_f32_32x32x16_bf16 v[48:63], v[84:87], a[16:19], v[48:63]
    s_waitcnt lgkmcnt(1)
    v_mfma_f32_32x32x16_bf16 v[16:31], v[88:91], a[24:27], v[16:31]
    ds_read_b128 v[80:83], v118 offset:4160
    s_waitcnt vmcnt(7)
    ds_read_b64_tr_b16 a[0:1], v123
    ds_read_b64_tr_b16 a[2:3], v123 offset:256
    v_mfma_f32_32x32x16_bf16 v[32:47], v[88:91], a[28:31], v[32:47]
    s_waitcnt lgkmcnt(3)
    v_mfma_f32_32x32x16_bf16 v[64:79], v[92:95], a[28:31], v[64:79]
    ds_read_b128 v[84:87], v118 offset:20800
    s_waitcnt vmcnt(6)
    ds_read_b64_tr_b16 a[4:5], v123 offset:1040
    ds_read_b64_tr_b16 a[6:7], v123 offset:1296
    s_mov_b32 m0, s34
    s_mov_b32 s30, 0x8000
    s_waitcnt lgkmcnt(3)
    buffer_load_dwordx4 v122, s[12:15], s30 offen lds
    v_mfma_f32_32x32x16_bf16 v[48:63], v[92:95], a[24:27], v[48:63]
    v_mfma_f32_32x32x16_bf16 v[16:31], v[80:83], a[32:35], v[16:31]
    ds_read_b128 v[88:91], v118 offset:4192
    s_waitcnt vmcnt(6)
    ds_read_b64_tr_b16 a[8:9], v123 offset:2080
    ds_read_b64_tr_b16 a[10:11], v123 offset:2336
    s_add_u32 m0, s34, 0x410
    s_mov_b32 s30, 0x8040
    s_waitcnt lgkmcnt(3)
    buffer_load_dwordx4 v122, s[12:15], s30 offen lds
    v_mfma_f32_32x32x16_bf16 v[32:47], v[80:83], a[36:39], v[32:47]
    v_mfma_f32_32x32x16_bf16 v[64:79], v[84:87], a[36:39], v[64:79]
    ds_read_b128 v[92:95], v118 offset:20832
    s_waitcnt vmcnt(6)
    ds_read_b64_tr_b16 a[12:13], v123 offset:3120
    ds_read_b64_tr_b16 a[14:15], v123 offset:3376
    s_add_u32 m0, s34, 0x820
    s_mov_b32 s30, 0xa000
    s_waitcnt lgkmcnt(3)
    buffer_load_dwordx4 v122, s[12:15], s30 offen lds
    v_mfma_f32_32x32x16_bf16 v[48:63], v[84:87], a[32:35], v[48:63]
    v_mfma_f32_32x32x16_bf16 v[16:31], v[88:91], a[40:43], v[16:31]
    ds_read_b128 v[80:83], v118 offset:4672
    s_waitcnt vmcnt(6)
    ds_read_b64_tr_b16 a[16:17], v123 offset:4160
    ds_read_b64_tr_b16 a[18:19], v123 offset:4416
    s_add_u32 m0, s34, 0xc30
    s_mov_b32 s30, 0xa040
    s_waitcnt lgkmcnt(3)
    buffer_load_dwordx4 v122, s[12:15], s30 offen lds
    v_mfma_f32_32x32x16_bf16 v[32:47], v[88:91], a[44:47], v[32:47]
    v_mfma_f32_32x32x16_bf16 v[64:79], v[92:95], a[44:47], v[64:79]
    ds_read_b128 v[84:87], v118 offset:21312
    s_waitcnt vmcnt(6)
    ds_read_b64_tr_b16 a[20:21], v123 offset:5200
    ds_read_b64_tr_b16 a[22:23], v123 offset:5456
    s_add_u32 m0, s34, 0x1040
    s_mov_b32 s30, 0xc000
    s_waitcnt lgkmcnt(3)
    buffer_load_dwordx4 v122, s[12:15], s30 offen lds
    v_mfma_f32_32x32x16_bf16 v[48:63], v[92:95], a[40:43], v[48:63]
    v_mfma_f32_32x32x16_bf16 v[16:31], v[80:83], a[48:51], v[16:31]
    ds_read_b128 v[88:91], v118 offset:4704
    s_waitcnt vmcnt(6)
    ds_read_b64_tr_b16 a[24:25], v123 offset:6240
    ds_read_b64_tr_b16 a[26:27], v123 offset:6496
    s_add_u32 m0, s34, 0x1450
    s_mov_b32 s30, 0xc040
    s_waitcnt lgkmcnt(3)
    buffer_load_dwordx4 v122, s[12:15], s30 offen lds
    v_mfma_f32_32x32x16_bf16 v[32:47], v[80:83], a[52:55], v[32:47]
    v_mfma_f32_32x32x16_bf16 v[64:79], v[84:87], a[52:55], v[64:79]
    ds_read_b128 v[92:95], v118 offset:21344
    s_waitcnt vmcnt(6)
    ds_read_b64_tr_b16 a[28:29], v123 offset:7280
    ds_read_b64_tr_b16 a[30:31], v123 offset:7536
    s_add_u32 m0, s34, 0x1860
    s_mov_b32 s30, 0xe000
    s_waitcnt lgkmcnt(3)
    buffer_load_dwordx4 v122, s[12:15], s30 offen lds
    v_mfma_f32_32x32x16_bf16 v[48:63], v[84:87], a[48:51], v[48:63]
    v_mfma_f32_32x32x16_bf16 v[16:31], v[88:91], a[56:59], v[16:31]
    ds_read_b128 v[80:83], v118 offset:8320
    s_waitcnt vmcnt(6)
    ds_read_b64_tr_b16 a[32:33], v123
    ds_read_b64_tr_b16 a[34:35], v123 offset:256
    s_add_u32 m0, s34, 0x1c70
    s_mov_b32 s30, 0xe040
    s_waitcnt lgkmcnt(3)
    buffer_load_dwordx4 v122, s[12:15], s30 offen lds
    v_mfma_f32_32x32x16_bf16 v[32:47], v[88:91], a[60:63], v[32:47]
    v_mfma_f32_32x32x16_bf16 v[64:79], v[92:95], a[60:63], v[64:79]
    ds_read_b128 v[84:87], v118 offset:24960
    s_waitcnt vmcnt(6)
    ds_read_b64_tr_b16 a[36:37], v123 offset:1040
    ds_read_b64_tr_b16 a[38:39], v123 offset:1296
    s_mov_b32 m0, s34
    s_mov_b32 s30, 0x10000
    s_waitcnt lgkmcnt(3)
    buffer_load_dwordx4 v122, s[12:15], s30 offen lds
    v_mfma_f32_32x32x16_bf16 v[48:63], v[92:95], a[56:59], v[48:63]
    v_mfma_f32_32x32x16_bf16 v[16:31], v[80:83], a[64:67], v[16:31]
    ds_read_b128 v[88:91], v118 offset:8352
    s_waitcnt vmcnt(6)
    ds_read_b64_tr_b16 a[40:41], v123 offset:2080
    ds_read_b64_tr_b16 a[42:43], v123 offset:2336
    s_add_u32 m0, s34, 0x410
    s_mov_b32 s30, 0x10040
    s_waitcnt lgkmcnt(3)
    buffer_load_dwordx4 v122, s[12:15], s30 offen lds
    v_mfma_f32_32x32x16_bf16 v[32:47], v[80:83], a[68:71], v[32:47]
    v_mfma_f32_32x32x16_bf16 v[64:79], v[84:87], a[68:71], v[64:79]
    ds_read_b128 v[92:95], v118 offset:24992
    s_waitcnt vmcnt(6)
    ds_read_b64_tr_b16 a[44:45], v123 offset:3120
    ds_read_b64_tr_b16 a[46:47], v123 offset:3376
    s_add_u32 m0, s34, 0x820
    s_mov_b32 s30, 0x12000
    s_waitcnt lgkmcnt(3)
    buffer_load_dwordx4 v122, s[12:15], s30 offen lds
    v_mfma_f32_32x32x16_bf16 v[48:63], v[84:87], a[64:67], v[48:63]
    v_mfma_f32_32x32x16_bf16 v[16:31], v[88:91], a[72:75], v[16:31]
    ds_read_b128 v[80:83], v118 offset:8832
    s_waitcnt vmcnt(6)
    ds_read_b64_tr_b16 a[48:49], v123 offset:4160
    ds_read_b64_tr_b16 a[50:51], v123 offset:4416
    s_add_u32 m0, s34, 0xc30
    s_mov_b32 s30, 0x12040
    s_waitcnt lgkmcnt(3)
    buffer_load_dwordx4 v122, s[12:15], s30 offen lds
    v_mfma_f32_32x32x16_bf16 v[32:47], v[88:91], a[76:79], v[32:47]
    v_mfma_f32_32x32x16_bf16 v[64:79], v[92:95], a[76:79], v[64:79]
    ds_read_b128 v[84:87], v118 offset:25472
    s_waitcnt vmcnt(6)
    ds_read_b64_tr_b16 a[52:53], v123 offset:5200
    ds_read_b64_tr_b16 a[54:55], v123 offset:5456
    s_add_u32 m0, s34, 0x1040
    s_mov_b32 s30, 0x14000
    s_waitcnt lgkmcnt(3)
    buffer_load_dwordx4 v122, s[12:15], s30 offen lds
    v_mfma_f32_32x32x16_bf16 v[48:63], v[92:95], a[72:75], v[48:63]
    v_mfma_f32_32x32x16_bf16 v[16:31], v[80:83], a[80:83], v[16:31]
    ds_read_b128 v[88:91], v118 offset:8864
    s_waitcnt vmcnt(6)
    ds_read_b64_tr_b16 a[56:57], v123 offset:6240
    ds_read_b64_tr_b16 a[58:59], v123 offset:6496
    s_add_u32 m0, s34, 0x1450
    s_mov_b32 s30, 0x14040
    s_waitcnt lgkmcnt(3)
    buffer_load_dwordx4 v122, s[12:15], s30 offen lds
    v_mfma_f32_32x32x16_bf16 v[32:47], v[80:83], a[84:87], v[32:47]
    v_mfma_f32_32x32x16_bf16 v[64:79], v[84:87], a[84:87], v[64:79]
    ds_read_b128 v[92:95], v118 offset:25504
    s_waitcnt vmcnt(6)
    ds_read_b64_tr_b16 a[60:61], v123 offset:7280
    ds_read_b64_tr_b16 a[62:63], v123 offset:7536
    s_add_u32 m0, s34, 0x1860
    s_mov_b32 s30, 0x16000
    s_waitcnt lgkmcnt(3)
    buffer_load_dwordx4 v122, s[12:15], s30 offen lds
    v_mfma_f32_32x32x16_bf16 v[48:63], v[84:87], a[80:83], v[48:63]
    v_mfma_f32_32x32x16_bf16 v[16:31], v[88:91], a[88:91], v[16:31]
    ds_read_b128 v[80:83], v118 offset:12480
    s_waitcnt vmcnt(6)
    ds_read_b64_tr_b16 a[64:65], v123
    ds_read_b64_tr_b16 a[66:67], v123 offset:256
    s_add_u32 m0, s34, 0x1c70
    s_mov_b32 s30, 0x16040
    s_waitcnt lgkmcnt(3)
    buffer_load_dwordx4 v122, s[12:15], s30 offen lds
    v_mfma_f32_32x32x16_bf16 v[32:47], v[88:91], a[92:95], v[32:47]
    v_mfma_f32_32x32x16_bf16 v[64:79], v[92:95], a[92:95], v[64:79]
    ds_read_b128 v[84:87], v118 offset:29120
    s_waitcnt vmcnt(6)
    ds_read_b64_tr_b16 a[68:69], v123 offset:1040
    ds_read_b64_tr_b16 a[70:71], v123 offset:1296
    s_mov_b32 m0, s34
    s_mov_b32 s30, 0x18000
    s_waitcnt lgkmcnt(3)
    buffer_load_dwordx4 v122, s[12:15], s30 offen lds
    v_mfma_f32_32x32x16_bf16 v[48:63], v[92:95], a[88:91], v[48:63]
    v_mfma_f32_32x32x16_bf16 v[16:31], v[80:83], a[96:99], v[16:31]
    ds_read_b128 v[88:91], v118 offset:12512
    s_waitcnt vmcnt(6)
    ds_read_b64_tr_b16 a[72:73], v123 offset:2080
    ds_read_b64_tr_b16 a[74:75], v123 offset:2336
    s_add_u32 m0, s34, 0x410
    s_mov_b32 s30, 0x18040
    s_waitcnt lgkmcnt(3)
    buffer_load_dwordx4 v122, s[12:15], s30 offen lds
    v_mfma_f32_32x32x16_bf16 v[32:47], v[80:83], a[100:103], v[32:47]
    v_mfma_f32_32x32x16_bf16 v[64:79], v[84:87], a[100:103], v[64:79]
    ds_read_b128 v[92:95], v118 offset:29152
    s_waitcnt vmcnt(6)
    ds_read_b64_tr_b16 a[76:77], v123 offset:3120
    ds_read_b64_tr_b16 a[78:79], v123 offset:3376
    s_add_u32 m0, s34, 0x820
    s_mov_b32 s30, 0x1a000
    s_waitcnt lgkmcnt(3)
    buffer_load_dwordx4 v122, s[12:15], s30 offen lds
    v_mfma_f32_32x32x16_bf16 v[48:63], v[84:87], a[96:99], v[48:63]
    v_mfma_f32_32x32x16_bf16 v[16:31], v[88:91], a[104:107], v[16:31]
    ds_read_b128 v[80:83], v118 offset:12992
    s_waitcnt vmcnt(6)
    ds_read_b64_tr_b16 a[80:81], v123 offset:4160
    ds_read_b64_tr_b16 a[82:83], v123 offset:4416
    s_add_u32 m0, s34, 0xc30
    s_mov_b32 s30, 0x1a040
    s_waitcnt lgkmcnt(3)
    buffer_load_dwordx4 v122, s[12:15], s30 offen lds
    v_mfma_f32_32x32x16_bf16 v[32:47], v[88:91], a[108:111], v[32:47]
    v_mfma_f32_32x32x16_bf16 v[64:79], v[92:95], a[108:111], v[64:79]
    ds_read_b128 v[84:87], v118 offset:29632
    s_waitcnt vmcnt(6)
    ds_read_b64_tr_b16 a[84:85], v123 offset:5200
    ds_read_b64_tr_b16 a[86:87], v123 offset:5456
    s_add_u32 m0, s34, 0x1040
    s_mov_b32 s30, 0x1c000
    s_waitcnt lgkmcnt(3)
    buffer_load_dwordx4 v122, s[12:15], s30 offen lds
    v_mfma_f32_32x32x16_bf16 v[48:63], v[92:95], a[104:107], v[48:63]
    v_mfma_f32_32x32x16_bf16 v[16:31], v[80:83], a[112:115], v[16:31]
    ds_read_b128 v[88:91], v118 offset:13024
    s_waitcnt vmcnt(6)
    ds_read_b64_tr_b16 a[88:89], v123 offset:6240
    ds_read_b64_tr_b16 a[90:91], v123 offset:6496
    s_add_u32 m0, s34, 0x1450
    s_mov_b32 s30, 0x1c040
    s_waitcnt lgkmcnt(3)
    buffer_load_dwordx4 v122, s[12:15], s30 offen lds
    v_mfma_f32_32x32x16_bf16 v[32:47], v[80:83], a[116:119], v[32:47]
    v_mfma_f32_32x32x16_bf16 v[64:79], v[84:87], a[116:119], v[64:79]
    ds_read_b128 v[92:95], v118 offset:29664
    s_waitcnt vmcnt(6)
    ds_read_b64_tr_b16 a[92:93], v123 offset:7280
    ds_read_b64_tr_b16 a[94:95], v123 offset:7536
    s_add_u32 m0, s34, 0x1860
    s_mov_b32 s30, 0x1e000
    s_waitcnt lgkmcnt(3)
    buffer_load_dwordx4 v122, s[12:15], s30 offen lds
    v_mfma_f32_32x32x16_bf16 v[48:63], v[84:87], a[112:115], v[48:63]
    v_mfma_f32_32x32x16_bf16 v[16:31], v[88:91], a[120:123], v[16:31]
    s_waitcnt vmcnt(6)
    ds_read_b64_tr_b16 a[96:97], v123
    ds_read_b64_tr_b16 a[98:99], v123 offset:256
    s_add_u32 m0, s34, 0x1c70
    s_mov_b32 s30, 0x1e040
    s_waitcnt lgkmcnt(2)
    buffer_load_dwordx4 v122, s[12:15], s30 offen lds
    v_mfma_f32_32x32x16_bf16 v[32:47], v[88:91], a[124:127], v[32:47]
    v_mfma_f32_32x32x16_bf16 v[64:79], v[92:95], a[124:127], v[64:79]
    s_waitcnt vmcnt(6)
    ds_read_b64_tr_b16 a[100:101], v123 offset:1040
    ds_read_b64_tr_b16 a[102:103], v123 offset:1296
    v_mfma_f32_32x32x16_bf16 v[48:63], v[92:95], a[120:123], v[48:63]
    s_setprio 0
    s_sub_u32 s35, s34, s29
    s_sub_u32 s35, s35, 0x1640
    v_add_u32 v121, s35, v121
    s_nop 2
    v_mul_f32 v32, s32, v32
    v_mul_f32 v33, s32, v33
    v_mul_f32 v34, s32, v34
    v_mul_f32 v35, s32, v35
    v_exp_f32 v32, v32
    s_waitcnt vmcnt(5)
    ds_read_b64_tr_b16 a[104:105], v123 offset:2080
    ds_read_b64_tr_b16 a[106:107], v123 offset:2336
    v_exp_f32 v33, v33
    s_waitcnt vmcnt(4)
    ds_read_b64_tr_b16 a[108:109], v123 offset:3120
    ds_read_b64_tr_b16 a[110:111], v123 offset:3376
    v_exp_f32 v34, v34
    s_waitcnt vmcnt(3)
    ds_read_b64_tr_b16 a[112:113], v123 offset:4160
    ds_read_b64_tr_b16 a[114:115], v123 offset:4416
    v_exp_f32 v35, v35
    s_waitcnt vmcnt(2)
    ds_read_b64_tr_b16 a[116:117], v123 offset:5200
    ds_read_b64_tr_b16 a[118:119], v123 offset:5456
    v_fma_f32 v32, v32, s33, s33
    v_fma_f32 v33, v33, s33, s33
    v_fma_f32 v34, v34, s33, s33
    v_fma_f32 v35, v35, s33, s33
    v_rcp_f32 v32, v32
    s_waitcnt vmcnt(1)
    ds_read_b64_tr_b16 a[120:121], v123 offset:6240
    ds_read_b64_tr_b16 a[122:123], v123 offset:6496
    v_rcp_f32 v33, v33
    s_waitcnt vmcnt(0)
    ds_read_b64_tr_b16 a[124:125], v123 offset:7280
    ds_read_b64_tr_b16 a[126:127], v123 offset:7536
    v_rcp_f32 v34, v34
    v_rcp_f32 v35, v35
    v_mul_f32 v16, v16, v32
    v_mul_f32 v17, v17, v33
    v_mul_f32 v18, v18, v34
    v_mul_f32 v19, v19, v35
    v_cvt_pk_bf16_f32 v32, v16, v17
    v_cvt_pk_bf16_f32 v33, v18, v19
    v_mul_f32 v36, s32, v36
    v_mul_f32 v37, s32, v37
    v_mul_f32 v38, s32, v38
    v_mul_f32 v39, s32, v39
    v_exp_f32 v36, v36
    v_exp_f32 v37, v37
    v_exp_f32 v38, v38
    v_exp_f32 v39, v39
    v_fma_f32 v36, v36, s33, s33
    v_fma_f32 v37, v37, s33, s33
    v_fma_f32 v38, v38, s33, s33
    v_fma_f32 v39, v39, s33, s33
    v_rcp_f32 v36, v36
    s_barrier
    v_rcp_f32 v37, v37
    v_rcp_f32 v38, v38
    v_rcp_f32 v39, v39
    v_mul_f32 v20, v20, v36
    v_mul_f32 v21, v21, v37
    v_mul_f32 v22, v22, v38
    v_mul_f32 v23, v23, v39
    v_cvt_pk_bf16_f32 v34, v20, v21
    v_cvt_pk_bf16_f32 v35, v22, v23
    ds_write_b128 v119, v[32:35] offset:32
    v_mul_f32 v40, s32, v40
    v_mul_f32 v41, s32, v41
    v_mul_f32 v42, s32, v42
    v_mul_f32 v43, s32, v43
    v_exp_f32 v40, v40
    v_exp_f32 v41, v41
    v_exp_f32 v42, v42
    v_exp_f32 v43, v43
    v_fma_f32 v40, v40, s33, s33
    v_fma_f32 v41, v41, s33, s33
    v_fma_f32 v42, v42, s33, s33
    v_fma_f32 v43, v43, s33, s33
    v_rcp_f32 v40, v40
    v_rcp_f32 v41, v41
    v_rcp_f32 v42, v42
    v_rcp_f32 v43, v43
    v_mul_f32 v24, v24, v40
    v_mul_f32 v25, v25, v41
    v_mul_f32 v26, v26, v42
    v_mul_f32 v27, v27, v43
    v_cvt_pk_bf16_f32 v36, v24, v25
    v_cvt_pk_bf16_f32 v37, v26, v27
    v_mul_f32 v44, s32, v44
    v_mul_f32 v45, s32, v45
    v_mul_f32 v46, s32, v46
    v_mul_f32 v47, s32, v47
    v_exp_f32 v44, v44
    v_exp_f32 v45, v45
    v_exp_f32 v46, v46
    v_exp_f32 v47, v47
    v_fma_f32 v44, v44, s33, s33
    v_fma_f32 v45, v45, s33, s33
    v_fma_f32 v46, v46, s33, s33
    v_fma_f32 v47, v47, s33, s33
    v_rcp_f32 v44, v44
    v_rcp_f32 v45, v45
    v_rcp_f32 v46, v46
    v_rcp_f32 v47, v47
    v_mul_f32 v28, v28, v44
    v_mul_f32 v29, v29, v45
    v_mul_f32 v30, v30, v46
    v_mul_f32 v31, v31, v47
    v_cvt_pk_bf16_f32 v38, v28, v29
    v_cvt_pk_bf16_f32 v39, v30, v31
    ds_write_b128 v119, v[36:39] offset:48
    ds_read_b128 v[16:19], v120 offset:32
    ds_read_b128 v[28:31], v120 offset:2848
    ds_read_b128 v[20:23], v120 offset:48
    ds_read_b128 v[40:43], v120 offset:2864
    ds_read_b128 v[24:27], v120 offset:64
    ds_read_b128 v[44:47], v120 offset:2880
    v_mul_f32 v64, s32, v64
    v_mul_f32 v65, s32, v65
    v_mul_f32 v66, s32, v66
    v_mul_f32 v67, s32, v67
    v_exp_f32 v64, v64
    v_exp_f32 v65, v65
    v_exp_f32 v66, v66
    v_exp_f32 v67, v67
    v_fma_f32 v64, v64, s33, s33
    v_fma_f32 v65, v65, s33, s33
    v_fma_f32 v66, v66, s33, s33
    v_fma_f32 v67, v67, s33, s33
    v_rcp_f32 v64, v64
    v_rcp_f32 v65, v65
    v_rcp_f32 v66, v66
    v_rcp_f32 v67, v67
    v_mul_f32 v48, v48, v64
    v_mul_f32 v49, v49, v65
    v_mul_f32 v50, v50, v66
    v_mul_f32 v51, v51, v67
    v_cvt_pk_bf16_f32 v64, v48, v49
    v_cvt_pk_bf16_f32 v65, v50, v51
    v_mul_f32 v68, s32, v68
    v_mul_f32 v69, s32, v69
    v_mul_f32 v70, s32, v70
    v_mul_f32 v71, s32, v71
    v_exp_f32 v68, v68
    v_exp_f32 v69, v69
    v_exp_f32 v70, v70
    v_exp_f32 v71, v71
    v_fma_f32 v68, v68, s33, s33
    v_fma_f32 v69, v69, s33, s33
    v_fma_f32 v70, v70, s33, s33
    v_fma_f32 v71, v71, s33, s33
    v_rcp_f32 v68, v68
    v_rcp_f32 v69, v69
    v_rcp_f32 v70, v70
    v_rcp_f32 v71, v71
    v_mul_f32 v52, v52, v68
    v_mul_f32 v53, v53, v69
    v_mul_f32 v54, v54, v70
    v_mul_f32 v55, v55, v71
    v_cvt_pk_bf16_f32 v66, v52, v53
    v_cvt_pk_bf16_f32 v67, v54, v55
    ds_write_b128 v119, v[64:67] offset:96
    v_mul_f32 v72, s32, v72
    v_mul_f32 v73, s32, v73
    v_mul_f32 v74, s32, v74
    v_mul_f32 v75, s32, v75
    v_exp_f32 v72, v72
    v_exp_f32 v73, v73
    v_exp_f32 v74, v74
    v_exp_f32 v75, v75
    v_fma_f32 v72, v72, s33, s33
    v_fma_f32 v73, v73, s33, s33
    v_fma_f32 v74, v74, s33, s33
    v_fma_f32 v75, v75, s33, s33
    v_rcp_f32 v72, v72
    v_rcp_f32 v73, v73
    v_rcp_f32 v74, v74
    v_rcp_f32 v75, v75
    v_mul_f32 v56, v56, v72
    v_mul_f32 v57, v57, v73
    v_mul_f32 v58, v58, v74
    v_mul_f32 v59, v59, v75
    v_cvt_pk_bf16_f32 v68, v56, v57
    v_cvt_pk_bf16_f32 v69, v58, v59
    v_mul_f32 v76, s32, v76
    v_mul_f32 v77, s32, v77
    v_mul_f32 v78, s32, v78
    v_mul_f32 v79, s32, v79
    v_exp_f32 v76, v76
    v_exp_f32 v77, v77
    v_exp_f32 v78, v78
    v_exp_f32 v79, v79
    v_fma_f32 v76, v76, s33, s33
    v_fma_f32 v77, v77, s33, s33
    v_fma_f32 v78, v78, s33, s33
    v_fma_f32 v79, v79, s33, s33
    v_rcp_f32 v76, v76
    v_rcp_f32 v77, v77
    v_rcp_f32 v78, v78
    v_rcp_f32 v79, v79
    v_mul_f32 v60, v60, v76
    v_mul_f32 v61, v61, v77
    v_mul_f32 v62, v62, v78
    v_mul_f32 v63, v63, v79
    v_cvt_pk_bf16_f32 v70, v60, v61
    v_cvt_pk_bf16_f32 v71, v62, v63
    ds_write_b128 v119, v[68:71] offset:112
    s_setprio 3
    s_waitcnt lgkmcnt(1)
    v_mfma_f32_4x4x4_16b_bf16 v[0:3], v[108:109], v[16:17], 0
    v_mfma_f32_4x4x4_16b_bf16 v[4:7], v[108:109], v[18:19], 0
    v_mfma_f32_4x4x4_16b_bf16 v[8:11], v[96:97], v[28:29], 0
    v_mfma_f32_4x4x4_16b_bf16 v[12:15], v[96:97], v[30:31], 0
    v_mfma_f32_4x4x4_16b_bf16 v[0:3], v[110:111], v[18:19], v[0:3]
    v_mfma_f32_4x4x4_16b_bf16 v[4:7], v[110:111], v[20:21], v[4:7]
    v_mfma_f32_4x4x4_16b_bf16 v[8:11], v[98:99], v[30:31], v[8:11]
    v_mfma_f32_4x4x4_16b_bf16 v[12:15], v[98:99], v[40:41], v[12:15]
    v_mfma_f32_4x4x4_16b_bf16 v[0:3], v[112:113], v[20:21], v[0:3]
    v_mfma_f32_4x4x4_16b_bf16 v[4:7], v[112:113], v[22:23], v[4:7]
    v_mfma_f32_4x4x4_16b_bf16 v[8:11], v[100:101], v[40:41], v[8:11]
    v_mfma_f32_4x4x4_16b_bf16 v[12:15], v[100:101], v[42:43], v[12:15]
    v_mfma_f32_4x4x4_16b_bf16 v[0:3], v[114:115], v[22:23], v[0:3]
    v_mfma_f32_4x4x4_16b_bf16 v[4:7], v[114:115], v[24:25], v[4:7]
    v_mfma_f32_4x4x4_16b_bf16 v[8:11], v[102:103], v[42:43], v[8:11]
    v_mfma_f32_4x4x4_16b_bf16 v[12:15], v[102:103], v[44:45], v[12:15]
    v_mfma_f32_4x4x4_16b_bf16 v[0:3], v[116:117], v[24:25], v[0:3]
    v_mfma_f32_4x4x4_16b_bf16 v[4:7], v[116:117], v[26:27], v[4:7]
    v_mfma_f32_4x4x4_16b_bf16 v[8:11], v[104:105], v[44:45], v[8:11]
    v_mfma_f32_4x4x4_16b_bf16 v[12:15], v[104:105], v[46:47], v[12:15]
    s_setprio 0
    ds_read_b128 v[16:19], v120 offset:96
    ds_read_b128 v[28:31], v120 offset:2912
    ds_read_b128 v[20:23], v120 offset:112
    ds_read_b128 v[40:43], v120 offset:2928
    ds_read_b128 v[24:27], v120 offset:128
    ds_read_b128 v[44:47], v120 offset:2944
    v_exp_f32 v32, v0
    v_exp_f32 v33, v1
    v_exp_f32 v34, v2
    v_exp_f32 v35, v3
    v_fma_f32 v32, v32, s32, s32
    v_fma_f32 v33, v33, s32, s32
    v_fma_f32 v34, v34, s32, s32
    v_fma_f32 v35, v35, s32, s32
    v_rcp_f32 v32, v32
    v_rcp_f32 v33, v33
    v_rcp_f32 v34, v34
    v_rcp_f32 v35, v35
    v_mul_f32 v0, v0, v32
    v_mul_f32 v1, v1, v33
    v_mul_f32 v2, v2, v34
    v_mul_f32 v3, v3, v35
    v_cvt_pk_bf16_f32 v0, v0, v1
    v_cvt_pk_bf16_f32 v1, v2, v3
    v_exp_f32 v36, v4
    v_exp_f32 v37, v5
    v_exp_f32 v38, v6
    v_exp_f32 v39, v7
    v_fma_f32 v36, v36, s32, s32
    v_fma_f32 v37, v37, s32, s32
    v_fma_f32 v38, v38, s32, s32
    v_fma_f32 v39, v39, s32, s32
    v_rcp_f32 v36, v36
    v_rcp_f32 v37, v37
    v_rcp_f32 v38, v38
    v_rcp_f32 v39, v39
    v_mul_f32 v4, v4, v36
    v_mul_f32 v5, v5, v37
    v_mul_f32 v6, v6, v38
    v_mul_f32 v7, v7, v39
    v_cvt_pk_bf16_f32 v2, v4, v5
    v_cvt_pk_bf16_f32 v3, v6, v7
    ds_write_b128 v121, v[0:3]
    v_exp_f32 v32, v8
    v_exp_f32 v33, v9
    v_exp_f32 v34, v10
    v_exp_f32 v35, v11
    v_fma_f32 v32, v32, s32, s32
    v_fma_f32 v33, v33, s32, s32
    v_fma_f32 v34, v34, s32, s32
    v_fma_f32 v35, v35, s32, s32
    v_rcp_f32 v32, v32
    v_rcp_f32 v33, v33
    v_rcp_f32 v34, v34
    v_rcp_f32 v35, v35
    v_mul_f32 v8, v8, v32
    v_mul_f32 v9, v9, v33
    v_mul_f32 v10, v10, v34
    v_mul_f32 v11, v11, v35
    v_cvt_pk_bf16_f32 v8, v8, v9
    v_cvt_pk_bf16_f32 v9, v10, v11
    v_exp_f32 v36, v12
    v_exp_f32 v37, v13
    v_exp_f32 v38, v14
    v_exp_f32 v39, v15
    v_fma_f32 v36, v36, s32, s32
    v_fma_f32 v37, v37, s32, s32
    v_fma_f32 v38, v38, s32, s32
    v_fma_f32 v39, v39, s32, s32
    v_rcp_f32 v36, v36
    v_rcp_f32 v37, v37
    v_rcp_f32 v38, v38
    v_rcp_f32 v39, v39
    v_mul_f32 v12, v12, v36
    v_mul_f32 v13, v13, v37
    v_mul_f32 v14, v14, v38
    v_mul_f32 v15, v15, v39
    v_cvt_pk_bf16_f32 v10, v12, v13
    v_cvt_pk_bf16_f32 v11, v14, v15
    ds_write_b128 v121, v[8:11] offset:1024
    s_setprio 3
    s_waitcnt lgkmcnt(1)
    v_mfma_f32_4x4x4_16b_bf16 v[0:3], v[108:109], v[16:17], 0
    v_mfma_f32_4x4x4_16b_bf16 v[4:7], v[108:109], v[18:19], 0
    v_mfma_f32_4x4x4_16b_bf16 v[8:11], v[96:97], v[28:29], 0
    v_mfma_f32_4x4x4_16b_bf16 v[12:15], v[96:97], v[30:31], 0
    v_mfma_f32_4x4x4_16b_bf16 v[0:3], v[110:111], v[18:19], v[0:3]
    v_mfma_f32_4x4x4_16b_bf16 v[4:7], v[110:111], v[20:21], v[4:7]
    v_mfma_f32_4x4x4_16b_bf16 v[8:11], v[98:99], v[30:31], v[8:11]
    v_mfma_f32_4x4x4_16b_bf16 v[12:15], v[98:99], v[40:41], v[12:15]
    v_mfma_f32_4x4x4_16b_bf16 v[0:3], v[112:113], v[20:21], v[0:3]
    v_mfma_f32_4x4x4_16b_bf16 v[4:7], v[112:113], v[22:23], v[4:7]
    v_mfma_f32_4x4x4_16b_bf16 v[8:11], v[100:101], v[40:41], v[8:11]
    v_mfma_f32_4x4x4_16b_bf16 v[12:15], v[100:101], v[42:43], v[12:15]
    v_mfma_f32_4x4x4_16b_bf16 v[0:3], v[114:115], v[22:23], v[0:3]
    v_mfma_f32_4x4x4_16b_bf16 v[4:7], v[114:115], v[24:25], v[4:7]
    v_mfma_f32_4x4x4_16b_bf16 v[8:11], v[102:103], v[42:43], v[8:11]
    v_mfma_f32_4x4x4_16b_bf16 v[12:15], v[102:103], v[44:45], v[12:15]
    v_mfma_f32_4x4x4_16b_bf16 v[0:3], v[116:117], v[24:25], v[0:3]
    v_mfma_f32_4x4x4_16b_bf16 v[4:7], v[116:117], v[26:27], v[4:7]
    v_mfma_f32_4x4x4_16b_bf16 v[8:11], v[104:105], v[44:45], v[8:11]
    v_mfma_f32_4x4x4_16b_bf16 v[12:15], v[104:105], v[46:47], v[12:15]
    s_setprio 0
    s_nop 0
    v_exp_f32 v32, v0
    v_exp_f32 v33, v1
    v_exp_f32 v34, v2
    v_exp_f32 v35, v3
    v_fma_f32 v32, v32, s32, s32
    v_fma_f32 v33, v33, s32, s32
    v_fma_f32 v34, v34, s32, s32
    v_fma_f32 v35, v35, s32, s32
    v_rcp_f32 v32, v32
    v_rcp_f32 v33, v33
    v_rcp_f32 v34, v34
    v_rcp_f32 v35, v35
    v_mul_f32 v0, v0, v32
    v_mul_f32 v1, v1, v33
    v_mul_f32 v2, v2, v34
    v_mul_f32 v3, v3, v35
    v_cvt_pk_bf16_f32 v0, v0, v1
    v_cvt_pk_bf16_f32 v1, v2, v3
    v_exp_f32 v36, v4
    v_exp_f32 v37, v5
    v_exp_f32 v38, v6
    v_exp_f32 v39, v7
    v_fma_f32 v36, v36, s32, s32
    v_fma_f32 v37, v37, s32, s32
    v_fma_f32 v38, v38, s32, s32
    v_fma_f32 v39, v39, s32, s32
    v_rcp_f32 v36, v36
    v_rcp_f32 v37, v37
    v_rcp_f32 v38, v38
    v_rcp_f32 v39, v39
    v_mul_f32 v4, v4, v36
    v_mul_f32 v5, v5, v37
    v_mul_f32 v6, v6, v38
    v_mul_f32 v7, v7, v39
    v_cvt_pk_bf16_f32 v2, v4, v5
    v_cvt_pk_bf16_f32 v3, v6, v7
    ds_write_b128 v121, v[0:3] offset:2048
    v_exp_f32 v32, v8
    v_exp_f32 v33, v9
    v_exp_f32 v34, v10
    v_exp_f32 v35, v11
    v_fma_f32 v32, v32, s32, s32
    v_fma_f32 v33, v33, s32, s32
    v_fma_f32 v34, v34, s32, s32
    v_fma_f32 v35, v35, s32, s32
    v_rcp_f32 v32, v32
    v_rcp_f32 v33, v33
    v_rcp_f32 v34, v34
    v_rcp_f32 v35, v35
    v_mul_f32 v8, v8, v32
    v_mul_f32 v9, v9, v33
    v_mul_f32 v10, v10, v34
    v_mul_f32 v11, v11, v35
    v_cvt_pk_bf16_f32 v8, v8, v9
    v_cvt_pk_bf16_f32 v9, v10, v11
    v_exp_f32 v36, v12
    v_exp_f32 v37, v13
    v_exp_f32 v38, v14
    v_exp_f32 v39, v15
    v_fma_f32 v36, v36, s32, s32
    v_fma_f32 v37, v37, s32, s32
    v_fma_f32 v38, v38, s32, s32
    v_fma_f32 v39, v39, s32, s32
    v_rcp_f32 v36, v36
    v_rcp_f32 v37, v37
    v_rcp_f32 v38, v38
    v_rcp_f32 v39, v39
    v_mul_f32 v12, v12, v36
    v_mul_f32 v13, v13, v37
    v_mul_f32 v14, v14, v38
    v_mul_f32 v15, v15, v39
    v_cvt_pk_bf16_f32 v10, v12, v13
    v_cvt_pk_bf16_f32 v11, v14, v15
    ds_write_b128 v121, v[8:11] offset:3072
    s_setprio 1
    ds_read_b64_tr_b16 v[80:81], v125
    ds_read_b64_tr_b16 v[82:83], v125 offset:256
    ds_read_b64_tr_b16 v[84:85], v125 offset:1024
    ds_read_b64_tr_b16 v[86:87], v125 offset:1280
    s_waitcnt lgkmcnt(2)
    v_mfma_f32_32x32x16_bf16 v[48:63], a[0:3], v[80:83], 0
    ds_read_b64_tr_b16 v[88:89], v125 offset:11120
    ds_read_b64_tr_b16 v[90:91], v125 offset:11376
    v_mfma_f32_32x32x16_bf16 v[64:79], a[4:7], v[80:83], 0
    s_waitcnt lgkmcnt(2)
    v_mfma_f32_32x32x16_bf16 v[48:63], a[8:11], v[84:87], v[48:63]
    ds_read_b64_tr_b16 v[92:93], v125 offset:12144
    ds_read_b64_tr_b16 v[94:95], v125 offset:12400
    v_mfma_f32_32x32x16_bf16 v[64:79], a[12:15], v[84:87], v[64:79]
    s_waitcnt lgkmcnt(2)
    v_mfma_f32_32x32x16_bf16 v[48:63], a[16:19], v[88:91], v[48:63]
    ds_read_b64_tr_b16 v[80:81], v125 offset:22240
    ds_read_b64_tr_b16 v[82:83], v125 offset:22496
    v_mfma_f32_32x32x16_bf16 v[64:79], a[20:23], v[88:91], v[64:79]
    s_waitcnt lgkmcnt(2)
    v_mfma_f32_32x32x16_bf16 v[48:63], a[24:27], v[92:95], v[48:63]
    ds_read_b64_tr_b16 v[84:85], v125 offset:23264
    ds_read_b64_tr_b16 v[86:87], v125 offset:23520
    v_mfma_f32_32x32x16_bf16 v[64:79], a[28:31], v[92:95], v[64:79]
    s_waitcnt lgkmcnt(2)
    v_mfma_f32_32x32x16_bf16 v[48:63], a[32:35], v[80:83], v[48:63]
    ds_read_b64_tr_b16 v[88:89], v125 offset:33360
    ds_read_b64_tr_b16 v[90:91], v125 offset:33616
    v_mfma_f32_32x32x16_bf16 v[64:79], a[36:39], v[80:83], v[64:79]
    s_waitcnt lgkmcnt(2)
    v_mfma_f32_32x32x16_bf16 v[48:63], a[40:43], v[84:87], v[48:63]
    ds_read_b64_tr_b16 v[92:93], v125 offset:34384
    ds_read_b64_tr_b16 v[94:95], v125 offset:34640
    v_mfma_f32_32x32x16_bf16 v[64:79], a[44:47], v[84:87], v[64:79]
    s_waitcnt lgkmcnt(2)
    v_mfma_f32_32x32x16_bf16 v[48:63], a[48:51], v[88:91], v[48:63]
    ds_read_b64_tr_b16 v[80:81], v126
    ds_read_b64_tr_b16 v[82:83], v126 offset:256
    v_mfma_f32_32x32x16_bf16 v[64:79], a[52:55], v[88:91], v[64:79]
    s_waitcnt lgkmcnt(2)
    v_mfma_f32_32x32x16_bf16 v[48:63], a[56:59], v[92:95], v[48:63]
    ds_read_b64_tr_b16 v[84:85], v126 offset:1024
    ds_read_b64_tr_b16 v[86:87], v126 offset:1280
    v_mfma_f32_32x32x16_bf16 v[64:79], a[60:63], v[92:95], v[64:79]
    s_waitcnt lgkmcnt(2)
    v_mfma_f32_32x32x16_bf16 v[48:63], a[64:67], v[80:83], v[48:63]
    ds_read_b64_tr_b16 v[88:89], v126 offset:11120
    ds_read_b64_tr_b16 v[90:91], v126 offset:11376
    v_mfma_f32_32x32x16_bf16 v[64:79], a[68:71], v[80:83], v[64:79]
    s_waitcnt lgkmcnt(2)
    v_mfma_f32_32x32x16_bf16 v[48:63], a[72:75], v[84:87], v[48:63]
    ds_read_b64_tr_b16 v[92:93], v126 offset:12144
    ds_read_b64_tr_b16 v[94:95], v126 offset:12400
    v_mfma_f32_32x32x16_bf16 v[64:79], a[76:79], v[84:87], v[64:79]
    s_waitcnt lgkmcnt(2)
    v_mfma_f32_32x32x16_bf16 v[48:63], a[80:83], v[88:91], v[48:63]
    ds_read_b64_tr_b16 v[80:81], v126 offset:22240
    ds_read_b64_tr_b16 v[82:83], v126 offset:22496
    v_mfma_f32_32x32x16_bf16 v[64:79], a[84:87], v[88:91], v[64:79]
    s_waitcnt lgkmcnt(2)
    v_mfma_f32_32x32x16_bf16 v[48:63], a[88:91], v[92:95], v[48:63]
    ds_read_b64_tr_b16 v[84:85], v126 offset:23264
    ds_read_b64_tr_b16 v[86:87], v126 offset:23520
    v_mfma_f32_32x32x16_bf16 v[64:79], a[92:95], v[92:95], v[64:79]
    s_waitcnt lgkmcnt(2)
    v_mfma_f32_32x32x16_bf16 v[48:63], a[96:99], v[80:83], v[48:63]
    ds_read_b64_tr_b16 v[88:89], v126 offset:33360
    ds_read_b64_tr_b16 v[90:91], v126 offset:33616
    v_mfma_f32_32x32x16_bf16 v[64:79], a[100:103], v[80:83], v[64:79]
    s_waitcnt lgkmcnt(2)
    v_mfma_f32_32x32x16_bf16 v[48:63], a[104:107], v[84:87], v[48:63]
    ds_read_b64_tr_b16 v[92:93], v126 offset:34384
    ds_read_b64_tr_b16 v[94:95], v126 offset:34640
    v_mfma_f32_32x32x16_bf16 v[64:79], a[108:111], v[84:87], v[64:79]
    s_waitcnt lgkmcnt(2)
    v_mfma_f32_32x32x16_bf16 v[48:63], a[112:115], v[88:91], v[48:63]
    ds_read_b64_tr_b16 v[80:81], v125 offset:2048
    ds_read_b64_tr_b16 v[82:83], v125 offset:2304
    v_mfma_f32_32x32x16_bf16 v[64:79], a[116:119], v[88:91], v[64:79]
    s_waitcnt lgkmcnt(2)
    v_mfma_f32_32x32x16_bf16 v[48:63], a[120:123], v[92:95], v[48:63]
    ds_read_b64_tr_b16 v[84:85], v125 offset:3072
    ds_read_b64_tr_b16 v[86:87], v125 offset:3328
    v_mfma_f32_32x32x16_bf16 v[64:79], a[124:127], v[92:95], v[64:79]
    s_waitcnt lgkmcnt(2)
    v_mfma_f32_32x32x16_bf16 v[16:31], a[0:3], v[80:83], 0
    ds_read_b64_tr_b16 v[88:89], v125 offset:13168
    ds_read_b64_tr_b16 v[90:91], v125 offset:13424
    v_mfma_f32_32x32x16_bf16 v[32:47], a[4:7], v[80:83], 0
    s_waitcnt lgkmcnt(2)
    v_mfma_f32_32x32x16_bf16 v[16:31], a[8:11], v[84:87], v[16:31]
    ds_read_b64_tr_b16 v[92:93], v125 offset:14192
    ds_read_b64_tr_b16 v[94:95], v125 offset:14448
    v_cvt_pk_bf16_f32 v48, v48, v49
    v_cvt_pk_bf16_f32 v49, v50, v51
    v_cvt_pk_bf16_f32 v50, v52, v53
    v_cvt_pk_bf16_f32 v51, v54, v55
    ds_write_b128 v127, v[48:51]
    v_mfma_f32_32x32x16_bf16 v[32:47], a[12:15], v[84:87], v[32:47]
    v_cvt_pk_bf16_f32 v52, v56, v57
    v_cvt_pk_bf16_f32 v53, v58, v59
    v_cvt_pk_bf16_f32 v54, v60, v61
    v_cvt_pk_bf16_f32 v55, v62, v63
    v_xor_b32 v96, 16, v127
    ds_write_b128 v96, v[52:55]
    s_waitcnt lgkmcnt(4)
    v_mfma_f32_32x32x16_bf16 v[16:31], a[16:19], v[88:91], v[16:31]
    ds_read_b64_tr_b16 v[80:81], v125 offset:24288
    ds_read_b64_tr_b16 v[82:83], v125 offset:24544
    v_cvt_pk_bf16_f32 v64, v64, v65
    v_cvt_pk_bf16_f32 v65, v66, v67
    v_cvt_pk_bf16_f32 v66, v68, v69
    v_cvt_pk_bf16_f32 v67, v70, v71
    v_xor_b32 v96, 64, v127
    ds_write_b128 v96, v[64:67]
    v_mfma_f32_32x32x16_bf16 v[32:47], a[20:23], v[88:91], v[32:47]
    v_cvt_pk_bf16_f32 v68, v72, v73
    v_cvt_pk_bf16_f32 v69, v74, v75
    v_cvt_pk_bf16_f32 v70, v76, v77
    v_cvt_pk_bf16_f32 v71, v78, v79
    v_xor_b32 v96, 0x50, v127
    ds_write_b128 v96, v[68:71]
    s_waitcnt lgkmcnt(5)
    v_mfma_f32_32x32x16_bf16 v[16:31], a[24:27], v[92:95], v[16:31]
    ds_read_b64_tr_b16 v[84:85], v125 offset:25312
    ds_read_b64_tr_b16 v[86:87], v125 offset:25568
    ds_read_b128 v[0:3], v106
    v_mfma_f32_32x32x16_bf16 v[32:47], a[28:31], v[92:95], v[32:47]
    ds_read_b128 v[4:7], v106 offset:1024
    s_waitcnt lgkmcnt(6)
    v_mfma_f32_32x32x16_bf16 v[16:31], a[32:35], v[80:83], v[16:31]
    ds_read_b64_tr_b16 v[88:89], v125 offset:35408
    ds_read_b64_tr_b16 v[90:91], v125 offset:35664
    ds_read_b128 v[8:11], v106 offset:2048
    v_mfma_f32_32x32x16_bf16 v[32:47], a[36:39], v[80:83], v[32:47]
    ds_read_b128 v[12:15], v106 offset:3072
    s_waitcnt lgkmcnt(5)
    v_mfma_f32_32x32x16_bf16 v[16:31], a[40:43], v[84:87], v[16:31]
    ds_read_b64_tr_b16 v[92:93], v125 offset:36432
    ds_read_b64_tr_b16 v[94:95], v125 offset:36688
    v_mfma_f32_32x32x16_bf16 v[32:47], a[44:47], v[84:87], v[32:47]
    s_waitcnt lgkmcnt(3)
    v_mfma_f32_32x32x16_bf16 v[16:31], a[48:51], v[88:91], v[16:31]
    ds_read_b64_tr_b16 v[80:81], v126 offset:2048
    ds_read_b64_tr_b16 v[82:83], v126 offset:2304
    s_mov_b32 s30, 0
    buffer_store_dwordx4 v[0:3], v107, s[20:23], s30 offen sc1
    v_mfma_f32_32x32x16_bf16 v[32:47], a[52:55], v[88:91], v[32:47]
    s_mov_b32 s30, 0x1000
    buffer_store_dwordx4 v[4:7], v107, s[20:23], s30 offen sc1
    s_waitcnt lgkmcnt(2)
    v_mfma_f32_32x32x16_bf16 v[16:31], a[56:59], v[92:95], v[16:31]
    ds_read_b64_tr_b16 v[84:85], v126 offset:3072
    ds_read_b64_tr_b16 v[86:87], v126 offset:3328
    s_mov_b32 s30, 0x2000
    buffer_store_dwordx4 v[8:11], v107, s[20:23], s30 offen sc1
    v_mfma_f32_32x32x16_bf16 v[32:47], a[60:63], v[92:95], v[32:47]
    s_mov_b32 s30, 0x3000
    buffer_store_dwordx4 v[12:15], v107, s[20:23], s30 offen sc1
    s_waitcnt lgkmcnt(2)
    v_mfma_f32_32x32x16_bf16 v[16:31], a[64:67], v[80:83], v[16:31]
    ds_read_b64_tr_b16 v[88:89], v126 offset:13168
    ds_read_b64_tr_b16 v[90:91], v126 offset:13424
    v_mfma_f32_32x32x16_bf16 v[32:47], a[68:71], v[80:83], v[32:47]
    s_waitcnt lgkmcnt(2)
    v_mfma_f32_32x32x16_bf16 v[16:31], a[72:75], v[84:87], v[16:31]
    ds_read_b64_tr_b16 v[92:93], v126 offset:14192
    ds_read_b64_tr_b16 v[94:95], v126 offset:14448
    v_mfma_f32_32x32x16_bf16 v[32:47], a[76:79], v[84:87], v[32:47]
    s_waitcnt lgkmcnt(2)
    v_mfma_f32_32x32x16_bf16 v[16:31], a[80:83], v[88:91], v[16:31]
    ds_read_b64_tr_b16 v[80:81], v126 offset:24288
    ds_read_b64_tr_b16 v[82:83], v126 offset:24544
    v_mfma_f32_32x32x16_bf16 v[32:47], a[84:87], v[88:91], v[32:47]
    s_waitcnt lgkmcnt(2)
    v_mfma_f32_32x32x16_bf16 v[16:31], a[88:91], v[92:95], v[16:31]
    ds_read_b64_tr_b16 v[84:85], v126 offset:25312
    ds_read_b64_tr_b16 v[86:87], v126 offset:25568
    v_mfma_f32_32x32x16_bf16 v[32:47], a[92:95], v[92:95], v[32:47]
    s_waitcnt lgkmcnt(2)
    v_mfma_f32_32x32x16_bf16 v[16:31], a[96:99], v[80:83], v[16:31]
    ds_read_b64_tr_b16 v[88:89], v126 offset:35408
    ds_read_b64_tr_b16 v[90:91], v126 offset:35664
    v_mfma_f32_32x32x16_bf16 v[32:47], a[100:103], v[80:83], v[32:47]
    s_waitcnt lgkmcnt(2)
    v_mfma_f32_32x32x16_bf16 v[16:31], a[104:107], v[84:87], v[16:31]
    ds_read_b64_tr_b16 v[92:93], v126 offset:36432
    ds_read_b64_tr_b16 v[94:95], v126 offset:36688
    v_mfma_f32_32x32x16_bf16 v[32:47], a[108:111], v[84:87], v[32:47]
    s_waitcnt lgkmcnt(2)
    v_mfma_f32_32x32x16_bf16 v[16:31], a[112:115], v[88:91], v[16:31]
    v_mfma_f32_32x32x16_bf16 v[32:47], a[116:119], v[88:91], v[32:47]
    s_waitcnt lgkmcnt(0)
    v_mfma_f32_32x32x16_bf16 v[16:31], a[120:123], v[92:95], v[16:31]
    v_mfma_f32_32x32x16_bf16 v[32:47], a[124:127], v[92:95], v[32:47]
    s_barrier
    ds_read_b64_tr_b16 v[80:81], v124
    ds_read_b64_tr_b16 v[82:83], v124 offset:256
    ds_read_b64_tr_b16 v[84:85], v124 offset:1024
    ds_read_b64_tr_b16 v[86:87], v124 offset:1280
    s_waitcnt lgkmcnt(2)
    v_mfma_f32_32x32x16_bf16 v[48:63], a[0:3], v[80:83], 0
    ds_read_b64_tr_b16 v[88:89], v124 offset:10400
    ds_read_b64_tr_b16 v[90:91], v124 offset:10656
    v_mfma_f32_32x32x16_bf16 v[64:79], a[4:7], v[80:83], 0
    s_waitcnt lgkmcnt(2)
    v_mfma_f32_32x32x16_bf16 v[48:63], a[8:11], v[84:87], v[48:63]
    ds_read_b64_tr_b16 v[92:93], v124 offset:11424
    ds_read_b64_tr_b16 v[94:95], v124 offset:11680
    v_cvt_pk_bf16_f32 v16, v16, v17
    v_cvt_pk_bf16_f32 v17, v18, v19
    v_cvt_pk_bf16_f32 v18, v20, v21
    v_cvt_pk_bf16_f32 v19, v22, v23
    ds_write_b128 v127, v[16:19]
    v_mfma_f32_32x32x16_bf16 v[64:79], a[12:15], v[84:87], v[64:79]
    v_cvt_pk_bf16_f32 v20, v24, v25
    v_cvt_pk_bf16_f32 v21, v26, v27
    v_cvt_pk_bf16_f32 v22, v28, v29
    v_cvt_pk_bf16_f32 v23, v30, v31
    v_xor_b32 v96, 16, v127
    ds_write_b128 v96, v[20:23]
    s_waitcnt lgkmcnt(4)
    v_mfma_f32_32x32x16_bf16 v[48:63], a[16:19], v[88:91], v[48:63]
    ds_read_b64_tr_b16 v[80:81], v124 offset:20800
    ds_read_b64_tr_b16 v[82:83], v124 offset:21056
    v_cvt_pk_bf16_f32 v32, v32, v33
    v_cvt_pk_bf16_f32 v33, v34, v35
    v_cvt_pk_bf16_f32 v34, v36, v37
    v_cvt_pk_bf16_f32 v35, v38, v39
    v_xor_b32 v96, 64, v127
    ds_write_b128 v96, v[32:35]
    v_mfma_f32_32x32x16_bf16 v[64:79], a[20:23], v[88:91], v[64:79]
    v_cvt_pk_bf16_f32 v36, v40, v41
    v_cvt_pk_bf16_f32 v37, v42, v43
    v_cvt_pk_bf16_f32 v38, v44, v45
    v_cvt_pk_bf16_f32 v39, v46, v47
    v_xor_b32 v96, 0x50, v127
    ds_write_b128 v96, v[36:39]
    s_waitcnt lgkmcnt(5)
    v_mfma_f32_32x32x16_bf16 v[48:63], a[24:27], v[92:95], v[48:63]
    ds_read_b64_tr_b16 v[84:85], v124 offset:21824
    ds_read_b64_tr_b16 v[86:87], v124 offset:22080
    v_mfma_f32_32x32x16_bf16 v[64:79], a[28:31], v[92:95], v[64:79]
    s_waitcnt lgkmcnt(4)
    v_mfma_f32_32x32x16_bf16 v[48:63], a[32:35], v[80:83], v[48:63]
    ds_read_b64_tr_b16 v[88:89], v124 offset:31200
    ds_read_b64_tr_b16 v[90:91], v124 offset:31456
    v_mfma_f32_32x32x16_bf16 v[64:79], a[36:39], v[80:83], v[64:79]
    s_waitcnt lgkmcnt(2)
    v_mfma_f32_32x32x16_bf16 v[48:63], a[40:43], v[84:87], v[48:63]
    ds_read_b64_tr_b16 v[92:93], v124 offset:32224
    ds_read_b64_tr_b16 v[94:95], v124 offset:32480
    s_barrier
    v_mfma_f32_32x32x16_bf16 v[64:79], a[44:47], v[84:87], v[64:79]
    s_waitcnt lgkmcnt(2)
    v_mfma_f32_32x32x16_bf16 v[48:63], a[48:51], v[88:91], v[48:63]
    ds_read_b64_tr_b16 v[80:81], v124 offset:8320
    ds_read_b64_tr_b16 v[82:83], v124 offset:8576
    v_mfma_f32_32x32x16_bf16 v[64:79], a[52:55], v[88:91], v[64:79]
    s_waitcnt lgkmcnt(2)
    v_mfma_f32_32x32x16_bf16 v[48:63], a[56:59], v[92:95], v[48:63]
    ds_read_b64_tr_b16 v[84:85], v124 offset:9344
    ds_read_b64_tr_b16 v[86:87], v124 offset:9600
    v_mfma_f32_32x32x16_bf16 v[64:79], a[60:63], v[92:95], v[64:79]
    s_waitcnt lgkmcnt(2)
    v_mfma_f32_32x32x16_bf16 v[48:63], a[64:67], v[80:83], v[48:63]
    ds_read_b64_tr_b16 v[88:89], v124 offset:18720
    ds_read_b64_tr_b16 v[90:91], v124 offset:18976
    v_mfma_f32_32x32x16_bf16 v[64:79], a[68:71], v[80:83], v[64:79]
    s_waitcnt lgkmcnt(2)
    v_mfma_f32_32x32x16_bf16 v[48:63], a[72:75], v[84:87], v[48:63]
    ds_read_b64_tr_b16 v[92:93], v124 offset:19744
    ds_read_b64_tr_b16 v[94:95], v124 offset:20000
    v_mfma_f32_32x32x16_bf16 v[64:79], a[76:79], v[84:87], v[64:79]
    s_waitcnt lgkmcnt(2)
    v_mfma_f32_32x32x16_bf16 v[48:63], a[80:83], v[88:91], v[48:63]
    ds_read_b64_tr_b16 v[80:81], v124 offset:29120
    ds_read_b64_tr_b16 v[82:83], v124 offset:29376
    v_mfma_f32_32x32x16_bf16 v[64:79], a[84:87], v[88:91], v[64:79]
    s_waitcnt lgkmcnt(2)
    v_mfma_f32_32x32x16_bf16 v[48:63], a[88:91], v[92:95], v[48:63]
    ds_read_b64_tr_b16 v[84:85], v124 offset:30144
    ds_read_b64_tr_b16 v[86:87], v124 offset:30400
    v_mfma_f32_32x32x16_bf16 v[64:79], a[92:95], v[92:95], v[64:79]
    s_waitcnt lgkmcnt(2)
    v_mfma_f32_32x32x16_bf16 v[48:63], a[96:99], v[80:83], v[48:63]
    ds_read_b64_tr_b16 v[88:89], v124 offset:39520
    ds_read_b64_tr_b16 v[90:91], v124 offset:39776
    v_mfma_f32_32x32x16_bf16 v[64:79], a[100:103], v[80:83], v[64:79]
    s_waitcnt lgkmcnt(2)
    v_mfma_f32_32x32x16_bf16 v[48:63], a[104:107], v[84:87], v[48:63]
    ds_read_b64_tr_b16 v[92:93], v124 offset:40544
    ds_read_b64_tr_b16 v[94:95], v124 offset:40800
    v_mfma_f32_32x32x16_bf16 v[64:79], a[108:111], v[84:87], v[64:79]
    s_waitcnt lgkmcnt(2)
    v_mfma_f32_32x32x16_bf16 v[48:63], a[112:115], v[88:91], v[48:63]
    ds_read_b64_tr_b16 v[80:81], v124 offset:2048
    ds_read_b64_tr_b16 v[82:83], v124 offset:2304
    v_mfma_f32_32x32x16_bf16 v[64:79], a[116:119], v[88:91], v[64:79]
    s_waitcnt lgkmcnt(2)
    v_mfma_f32_32x32x16_bf16 v[48:63], a[120:123], v[92:95], v[48:63]
    ds_read_b64_tr_b16 v[84:85], v124 offset:3072
    ds_read_b64_tr_b16 v[86:87], v124 offset:3328
    v_mfma_f32_32x32x16_bf16 v[64:79], a[124:127], v[92:95], v[64:79]
    s_waitcnt lgkmcnt(2)
    v_mfma_f32_32x32x16_bf16 v[16:31], a[0:3], v[80:83], 0
    ds_read_b64_tr_b16 v[88:89], v124 offset:12448
    ds_read_b64_tr_b16 v[90:91], v124 offset:12704
    v_mfma_f32_32x32x16_bf16 v[32:47], a[4:7], v[80:83], 0
    s_waitcnt lgkmcnt(2)
    v_mfma_f32_32x32x16_bf16 v[16:31], a[8:11], v[84:87], v[16:31]
    ds_read_b64_tr_b16 v[92:93], v124 offset:13472
    ds_read_b64_tr_b16 v[94:95], v124 offset:13728
    v_cvt_pk_bf16_f32 v48, v48, v49
    v_cvt_pk_bf16_f32 v49, v50, v51
    v_cvt_pk_bf16_f32 v50, v52, v53
    v_cvt_pk_bf16_f32 v51, v54, v55
    ds_write_b128 v127, v[48:51] offset:45696
    v_mfma_f32_32x32x16_bf16 v[32:47], a[12:15], v[84:87], v[32:47]
    v_cvt_pk_bf16_f32 v52, v56, v57
    v_cvt_pk_bf16_f32 v53, v58, v59
    v_cvt_pk_bf16_f32 v54, v60, v61
    v_cvt_pk_bf16_f32 v55, v62, v63
    v_xor_b32 v96, 16, v127
    ds_write_b128 v96, v[52:55] offset:45696
    s_waitcnt lgkmcnt(4)
    v_mfma_f32_32x32x16_bf16 v[16:31], a[16:19], v[88:91], v[16:31]
    ds_read_b64_tr_b16 v[80:81], v124 offset:22848
    ds_read_b64_tr_b16 v[82:83], v124 offset:23104
    v_cvt_pk_bf16_f32 v64, v64, v65
    v_cvt_pk_bf16_f32 v65, v66, v67
    v_cvt_pk_bf16_f32 v66, v68, v69
    v_cvt_pk_bf16_f32 v67, v70, v71
    v_xor_b32 v96, 64, v127
    ds_write_b128 v96, v[64:67] offset:45696
    v_mfma_f32_32x32x16_bf16 v[32:47], a[20:23], v[88:91], v[32:47]
    v_cvt_pk_bf16_f32 v68, v72, v73
    v_cvt_pk_bf16_f32 v69, v74, v75
    v_cvt_pk_bf16_f32 v70, v76, v77
    v_cvt_pk_bf16_f32 v71, v78, v79
    v_xor_b32 v96, 0x50, v127
    ds_write_b128 v96, v[68:71] offset:45696
    s_waitcnt lgkmcnt(5)
    v_mfma_f32_32x32x16_bf16 v[16:31], a[24:27], v[92:95], v[16:31]
    ds_read_b64_tr_b16 v[84:85], v124 offset:23872
    ds_read_b64_tr_b16 v[86:87], v124 offset:24128
    v_mfma_f32_32x32x16_bf16 v[32:47], a[28:31], v[92:95], v[32:47]
    s_waitcnt lgkmcnt(4)
    v_mfma_f32_32x32x16_bf16 v[16:31], a[32:35], v[80:83], v[16:31]
    ds_read_b64_tr_b16 v[88:89], v124 offset:33248
    ds_read_b64_tr_b16 v[90:91], v124 offset:33504
    v_mfma_f32_32x32x16_bf16 v[32:47], a[36:39], v[80:83], v[32:47]
    s_waitcnt lgkmcnt(2)
    v_mfma_f32_32x32x16_bf16 v[16:31], a[40:43], v[84:87], v[16:31]
    ds_read_b64_tr_b16 v[92:93], v124 offset:34272
    ds_read_b64_tr_b16 v[94:95], v124 offset:34528
    v_mfma_f32_32x32x16_bf16 v[32:47], a[44:47], v[84:87], v[32:47]
    s_waitcnt lgkmcnt(2)
    v_mfma_f32_32x32x16_bf16 v[16:31], a[48:51], v[88:91], v[16:31]
    v_mfma_f32_32x32x16_bf16 v[32:47], a[52:55], v[88:91], v[32:47]
    s_waitcnt lgkmcnt(0)
    v_mfma_f32_32x32x16_bf16 v[16:31], a[56:59], v[92:95], v[16:31]
    v_mfma_f32_32x32x16_bf16 v[32:47], a[60:63], v[92:95], v[32:47]
    s_barrier
    ds_read_b64_tr_b16 v[80:81], v124 offset:41600
    ds_read_b64_tr_b16 v[82:83], v124 offset:41856
    ds_read_b64_tr_b16 v[84:85], v124 offset:42624
    ds_read_b64_tr_b16 v[86:87], v124 offset:42880
    s_waitcnt lgkmcnt(2)
    v_mfma_f32_32x32x16_bf16 v[16:31], a[64:67], v[80:83], v[16:31]
    ds_read_b64_tr_b16 v[88:89], v124 offset:43648
    ds_read_b64_tr_b16 v[90:91], v124 offset:43904
    v_mfma_f32_32x32x16_bf16 v[32:47], a[68:71], v[80:83], v[32:47]
    s_waitcnt lgkmcnt(2)
    v_mfma_f32_32x32x16_bf16 v[16:31], a[72:75], v[84:87], v[16:31]
    ds_read_b64_tr_b16 v[92:93], v124 offset:44672
    ds_read_b64_tr_b16 v[94:95], v124 offset:44928
    v_mfma_f32_32x32x16_bf16 v[32:47], a[76:79], v[84:87], v[32:47]
    s_waitcnt lgkmcnt(2)
    v_mfma_f32_32x32x16_bf16 v[16:31], a[80:83], v[88:91], v[16:31]
    ds_read_b64_tr_b16 v[80:81], v124 offset:45696
    ds_read_b64_tr_b16 v[82:83], v124 offset:45952
    v_mfma_f32_32x32x16_bf16 v[32:47], a[84:87], v[88:91], v[32:47]
    s_waitcnt lgkmcnt(2)
    v_mfma_f32_32x32x16_bf16 v[16:31], a[88:91], v[92:95], v[16:31]
    ds_read_b64_tr_b16 v[84:85], v124 offset:46720
    ds_read_b64_tr_b16 v[86:87], v124 offset:46976
    v_mfma_f32_32x32x16_bf16 v[32:47], a[92:95], v[92:95], v[32:47]
    s_waitcnt lgkmcnt(2)
    v_mfma_f32_32x32x16_bf16 v[16:31], a[96:99], v[80:83], v[16:31]
    ds_read_b64_tr_b16 v[88:89], v124 offset:47744
    ds_read_b64_tr_b16 v[90:91], v124 offset:48000
    v_mfma_f32_32x32x16_bf16 v[32:47], a[100:103], v[80:83], v[32:47]
    s_waitcnt lgkmcnt(2)
    v_mfma_f32_32x32x16_bf16 v[16:31], a[104:107], v[84:87], v[16:31]
    ds_read_b64_tr_b16 v[92:93], v124 offset:48768
    ds_read_b64_tr_b16 v[94:95], v124 offset:49024
    v_mfma_f32_32x32x16_bf16 v[32:47], a[108:111], v[84:87], v[32:47]
    s_waitcnt lgkmcnt(2)
    v_mfma_f32_32x32x16_bf16 v[16:31], a[112:115], v[88:91], v[16:31]
    v_mfma_f32_32x32x16_bf16 v[32:47], a[116:119], v[88:91], v[32:47]
    s_waitcnt lgkmcnt(0)
    v_mfma_f32_32x32x16_bf16 v[16:31], a[120:123], v[92:95], v[16:31]
    v_mfma_f32_32x32x16_bf16 v[32:47], a[124:127], v[92:95], v[32:47]
    s_nop 7
    s_nop 2
    v_cvt_pk_bf16_f32 v16, v16, v17
    v_cvt_pk_bf16_f32 v17, v18, v19
    v_cvt_pk_bf16_f32 v18, v20, v21
    v_cvt_pk_bf16_f32 v19, v22, v23
    ds_write_b128 v127, v[16:19]
    v_cvt_pk_bf16_f32 v20, v24, v25
    v_cvt_pk_bf16_f32 v21, v26, v27
    v_cvt_pk_bf16_f32 v22, v28, v29
    v_cvt_pk_bf16_f32 v23, v30, v31
    v_xor_b32 v96, 16, v127
    ds_write_b128 v96, v[20:23]
    v_cvt_pk_bf16_f32 v32, v32, v33
    v_cvt_pk_bf16_f32 v33, v34, v35
    v_cvt_pk_bf16_f32 v34, v36, v37
    v_cvt_pk_bf16_f32 v35, v38, v39
    v_xor_b32 v96, 64, v127
    ds_write_b128 v96, v[32:35]
    v_cvt_pk_bf16_f32 v36, v40, v41
    v_cvt_pk_bf16_f32 v37, v42, v43
    v_cvt_pk_bf16_f32 v38, v44, v45
    v_cvt_pk_bf16_f32 v39, v46, v47
    v_xor_b32 v96, 0x50, v127
    ds_write_b128 v96, v[36:39]
    ds_read_b128 v[0:3], v106
    ds_read_b128 v[4:7], v106 offset:1024
    ds_read_b128 v[8:11], v106 offset:2048
    ds_read_b128 v[12:15], v106 offset:3072
    s_mov_b32 s30, 0xc000
    s_waitcnt lgkmcnt(3)
    buffer_store_dwordx4 v[0:3], v107, s[20:23], s30 offen sc1
    s_mov_b32 s30, 0xd000
    s_waitcnt lgkmcnt(2)
    buffer_store_dwordx4 v[4:7], v107, s[20:23], s30 offen sc1
    s_mov_b32 s30, 0xe000
    s_waitcnt lgkmcnt(1)
    buffer_store_dwordx4 v[8:11], v107, s[20:23], s30 offen sc1
    s_mov_b32 s30, 0xf000
    s_waitcnt lgkmcnt(0)
    buffer_store_dwordx4 v[12:15], v107, s[20:23], s30 offen sc1
    s_endpgm
L_B2:
    v_mov_b32 v116, v6
    v_bfe_u32 v8, v0, 0, 1
    v_bfe_u32 v9, v0, 1, 1
    v_bfe_u32 v10, v0, 2, 1
    v_bfe_u32 v11, v0, 3, 1
    v_bfe_u32 v12, v0, 4, 1
    v_bfe_u32 v13, v0, 2, 2
    v_bfe_u32 v14, v0, 0, 4
    v_bfe_u32 v15, v0, 0, 5
    v_bfe_u32 v16, v0, 0, 3
    v_bfe_u32 v17, v0, 4, 2
    v_bfe_u32 v18, v0, 3, 3
    v_bfe_u32 v19, v0, 3, 2
    v_bfe_u32 v20, v0, 0, 6
    v_mul_u32_u24 v118, 0x820, v10
    s_mov_b32 s36, 0x410
    v_mad_u32_u24 v118, v12, s36, v118
    v_lshl_add_u32 v118, v11, 8, v118
    v_lshl_add_u32 v118, v4, 6, v118
    v_lshl_add_u32 v118, v3, 4, v118
    v_mul_u32_u24 v108, 0x410, v11
    v_lshl_add_u32 v108, v16, 6, v108
    v_lshl_add_u32 v108, v12, 5, v108
    v_lshl_add_u32 v108, v3, 4, v108
    v_lshlrev_b32 v124, 9, v3
    v_lshl_add_u32 v124, v13, 6, v124
    v_lshl_add_u32 v124, v4, 3, v124
    v_mul_u32_u24 v109, 0x820, v12
    v_add_u32 v109, v124, v109
    v_add_u32 v109, s29, v109
    v_lshl_add_u32 v124, v12, 5, v124
    s_sub_u32 s94, s41, s29
    v_add_u32 v111, s29, v124
    v_bcnt_u32_b32 v25, v2, 0
    v_and_b32 v25, 1, v25
    v_lshlrev_b32 v24, 1, v3
    v_lshl_add_u32 v24, v19, 2, v24
    v_add_u32 v24, v25, v24
    s_add_u32 s35, s29, 0x248e
    v_lshlrev_b32 v25, 1, v4
    v_sub_u32 v25, s35, v25
    v_mul_u32_u24 v112, 40, v24
    v_add_u32 v112, v25, v112
    s_add_u32 s35, s29, 32
    v_mul_u32_u24 v119, 0xb0, v15
    v_lshl_add_u32 v119, v3, 5, v119
    v_add_u32 v119, s35, v119
    v_mul_u32_u24 v113, 0xb0, v14
    v_lshl_add_u32 v113, v17, 3, v113
    v_add_u32 v113, s35, v113
    v_mul_u32_u24 v120, 0xb0, v24
    v_lshl_add_u32 v120, v4, 4, v120
    v_add_u32 v120, s29, v120
    s_add_u32 s35, s29, 0x1640
    v_lshlrev_b32 v121, 6, v24
    v_lshl_add_u32 v121, v4, 4, v121
    v_add_u32 v121, s35, v121
    s_mov_b32 s32, 0xbfb8aa3b
    s_mov_b32 s33, 0xbf317218
    v_add_u32 v117, 0x4000, v110
    s_mov_b32 m0, s42
    s_mov_b32 s30, 0x10000
    buffer_load_dwordx4 v110, s[8:11], s30 offen lds
    s_add_u32 m0, s42, 0x820
    s_mov_b32 s30, 0x14000
    buffer_load_dwordx4 v110, s[8:11], s30 offen lds
    s_add_u32 m0, s42, 0x410
    s_mov_b32 s30, 0x10200
    buffer_load_dwordx4 v110, s[8:11], s30 offen lds
    s_add_u32 m0, s42, 0xc30
    s_mov_b32 s30, 0x14200
    buffer_load_dwordx4 v110, s[8:11], s30 offen lds
    s_barrier
    s_add_u32 m0, s42, 0x1040
    s_mov_b32 s30, 0x18000
    buffer_load_dwordx4 v110, s[8:11], s30 offen lds
    s_add_u32 m0, s42, 0x1860
    s_mov_b32 s30, 0x1c000
    buffer_load_dwordx4 v110, s[8:11], s30 offen lds
    s_add_u32 m0, s42, 0x1450
    s_mov_b32 s30, 0x18200
    buffer_load_dwordx4 v110, s[8:11], s30 offen lds
    s_add_u32 m0, s42, 0x1c70
    s_mov_b32 s30, 0x1c200
    buffer_load_dwordx4 v110, s[8:11], s30 offen lds
    s_add_u32 m0, s38, 0x4100
    s_add_u32 s30, s37, 0x1100
    buffer_load_dwordx4 v6, s[4:7], s30 offen lds
    s_add_u32 m0, s38, 0x4510
    s_add_u32 s30, s37, 0x2100
    buffer_load_dwordx4 v6, s[4:7], s30 offen lds
    s_and_b32 s35, s39, 1
    s_lshl_b32 s35, s35, 12
    s_lshr_b32 s36, s39, 1
    s_lshl_b32 s36, s36, 7
    s_add_u32 s35, s35, s36
    s_add_u32 s35, s35, s31
    s_sub_u32 s35, s35, 0x1000
    v_add_u32 v7, s35, v6
    s_mul_i32 s95, s39, 0x410
    s_add_u32 m0, s95, 0x1040
    s_mov_b32 s30, 0x100
    buffer_load_dwordx4 v7, s[4:7], s30 offen lds
    s_waitcnt vmcnt(13)
    s_barrier
    s_mov_b32 m0, s43
    s_mov_b32 s30, 0x20000
    buffer_load_dwordx4 v110, s[8:11], s30 offen lds
    s_add_u32 m0, s43, 0x820
    s_mov_b32 s30, 0x24000
    buffer_load_dwordx4 v110, s[8:11], s30 offen lds
    s_add_u32 m0, s43, 0x410
    s_mov_b32 s30, 0x20200
    buffer_load_dwordx4 v110, s[8:11], s30 offen lds
    s_add_u32 m0, s43, 0xc30
    s_mov_b32 s30, 0x24200
    buffer_load_dwordx4 v110, s[8:11], s30 offen lds
    s_waitcnt vmcnt(11)
    s_barrier
    s_add_u32 m0, s43, 0x1040
    s_mov_b32 s30, 0x28000
    buffer_load_dwordx4 v110, s[8:11], s30 offen lds
    s_add_u32 m0, s43, 0x1860
    s_mov_b32 s30, 0x2c000
    buffer_load_dwordx4 v110, s[8:11], s30 offen lds
    s_add_u32 m0, s43, 0x1450
    s_mov_b32 s30, 0x28200
    buffer_load_dwordx4 v110, s[8:11], s30 offen lds
    s_add_u32 m0, s43, 0x1c70
    s_mov_b32 s30, 0x2c200
    buffer_load_dwordx4 v110, s[8:11], s30 offen lds
    s_add_u32 m0, s38, 0x5140
    s_add_u32 s30, s37, 0x1180
    buffer_load_dwordx4 v6, s[4:7], s30 offen lds
    s_add_u32 m0, s38, 0x5550
    s_add_u32 s30, s37, 0x2180
    buffer_load_dwordx4 v6, s[4:7], s30 offen lds
    s_lshl_b32 s37, s39, 7
    s_add_u32 s37, s37, s31
    s_waitcnt vmcnt(13)
    s_barrier
    s_mov_b32 m0, s42
    s_mov_b32 s30, 0x30000
    buffer_load_dwordx4 v110, s[8:11], s30 offen lds
    s_add_u32 m0, s42, 0x820
    s_mov_b32 s30, 0x34000
    buffer_load_dwordx4 v110, s[8:11], s30 offen lds
    s_add_u32 m0, s42, 0x410
    s_mov_b32 s30, 0x30200
    buffer_load_dwordx4 v110, s[8:11], s30 offen lds
    s_add_u32 m0, s42, 0xc30
    s_mov_b32 s30, 0x34200
    buffer_load_dwordx4 v110, s[8:11], s30 offen lds
    s_waitcnt vmcnt(10)
    s_barrier
    s_add_u32 m0, s42, 0x1040
    s_mov_b32 s30, 0x38000
    buffer_load_dwordx4 v110, s[8:11], s30 offen lds
    s_add_u32 m0, s42, 0x1860
    s_mov_b32 s30, 0x3c000
    buffer_load_dwordx4 v110, s[8:11], s30 offen lds
    s_add_u32 m0, s42, 0x1450
    s_mov_b32 s30, 0x38200
    buffer_load_dwordx4 v110, s[8:11], s30 offen lds
    s_add_u32 m0, s42, 0x1c70
    s_mov_b32 s30, 0x3c200
    buffer_load_dwordx4 v110, s[8:11], s30 offen lds
    s_waitcnt vmcnt(10)
    s_barrier
    s_mov_b32 m0, s29
    s_mov_b32 s30, 0x100
    buffer_load_dwordx4 v110, s[8:11], s30 offen lds
    s_add_u32 m0, s29, 0x820
    s_mov_b32 s30, 0x4100
    buffer_load_dwordx4 v110, s[8:11], s30 offen lds
    s_add_u32 m0, s29, 0x410
    s_mov_b32 s30, 0x300
    buffer_load_dwordx4 v110, s[8:11], s30 offen lds
    s_add_u32 m0, s29, 0xc30
    s_mov_b32 s30, 0x4300
    buffer_load_dwordx4 v110, s[8:11], s30 offen lds
    s_waitcnt vmcnt(8)
    s_barrier
    s_add_u32 m0, s29, 0x1040
    s_mov_b32 s30, 0x8100
    buffer_load_dwordx4 v110, s[8:11], s30 offen lds
    s_add_u32 m0, s29, 0x1860
    s_mov_b32 s30, 0xc100
    buffer_load_dwordx4 v110, s[8:11], s30 offen lds
    s_add_u32 m0, s29, 0x1450
    s_mov_b32 s30, 0x8300
    buffer_load_dwordx4 v110, s[8:11], s30 offen lds
    s_add_u32 m0, s29, 0x1c70
    s_mov_b32 s30, 0xc300
    buffer_load_dwordx4 v110, s[8:11], s30 offen lds
    s_mov_b32 m0, s41
    s_mov_b32 s30, 0x10100
    buffer_load_dwordx4 v110, s[8:11], s30 offen lds
    s_add_u32 m0, s41, 0x820
    s_mov_b32 s30, 0x14100
    buffer_load_dwordx4 v110, s[8:11], s30 offen lds
    s_add_u32 m0, s41, 0x410
    s_mov_b32 s30, 0x10300
    buffer_load_dwordx4 v110, s[8:11], s30 offen lds
    s_add_u32 m0, s41, 0xc30
    s_mov_b32 s30, 0x14300
    buffer_load_dwordx4 v110, s[8:11], s30 offen lds
    s_waitcnt vmcnt(12)
    s_barrier
    s_add_u32 m0, s41, 0xffffbf00
    s_add_u32 s30, s37, 0x9000
    buffer_load_dwordx4 v116, s[4:7], s30 offen lds
    s_add_u32 m0, s41, 0xffffc310
    s_add_u32 s30, s37, 0xa000
    buffer_load_dwordx4 v116, s[4:7], s30 offen lds
    s_add_u32 m0, s41, 0xffffc720
    s_add_u32 s30, s37, 0xb000
    buffer_load_dwordx4 v116, s[4:7], s30 offen lds
    s_add_u32 m0, s41, 0xffffcb30
    s_add_u32 s30, s37, 0xc000
    buffer_load_dwordx4 v116, s[4:7], s30 offen lds
    s_lshr_b32 s35, s2, 3
    s_and_b32 s35, s35, 31
    s_lshl_b32 s35, s35, 2
    s_add_u32 s35, s35, s39
    s_lshl_b32 s35, s35, 10
    v_and_b32 v115, 63, v0
    v_lshlrev_b32 v115, 4, v115
    buffer_load_dword v115, v115, s[12:15], s35 offen
    s_setprio 1
    ds_read_b128 v[80:83], v118 offset:8320
    s_waitcnt vmcnt(16)
    ds_read_b64_tr_b16 a[0:1], v111
    ds_read_b64_tr_b16 a[2:3], v111 offset:256
    s_waitcnt vmcnt(14)
    ds_read_b64_tr_b16 a[4:5], v111 offset:1040
    ds_read_b64_tr_b16 a[6:7], v111 offset:1296
    ds_read_b128 v[96:99], v108
    ds_read_b64_tr_b16 v[100:101], v109
    ds_read_b64_tr_b16 v[102:103], v109 offset:256
    ds_read_b128 v[84:87], v118 offset:24960
    ds_read_b64_tr_b16 v[104:105], v109 offset:32
    ds_read_b64_tr_b16 v[106:107], v109 offset:288
    ds_read_b128 v[88:91], v118 offset:8352
    ds_read_b64_tr_b16 a[8:9], v111 offset:2080
    ds_read_b64_tr_b16 a[10:11], v111 offset:2336
    s_waitcnt vmcnt(13)
    ds_read_b64_tr_b16 a[12:13], v111 offset:3120
    ds_read_b64_tr_b16 a[14:15], v111 offset:3376
    ds_read_b128 v[92:95], v118 offset:24992
    s_waitcnt lgkmcnt(14)
    v_mfma_f32_32x32x16_bf16 v[16:31], v[80:83], a[0:3], 0
    ds_read_b128 v[122:125], v108 offset:512
    s_waitcnt lgkmcnt(13)
    v_mfma_f32_32x32x16_bf16 v[32:47], v[80:83], a[4:7], 0
    ds_read_b128 v[80:83], v118 offset:8832
    s_waitcnt lgkmcnt(11)
    v_mfma_f32_16x16x32_bf16 v[0:3], v[96:99], v[100:103], 0
    ds_read_b64_tr_b16 v[100:101], v109 offset:1040
    ds_read_b64_tr_b16 v[102:103], v109 offset:1296
    s_waitcnt lgkmcnt(9)
    v_mfma_f32_32x32x16_bf16 v[48:63], v[84:87], a[0:3], 0
    s_waitcnt vmcnt(12)
    ds_read_b64_tr_b16 a[16:17], v111 offset:4160
    ds_read_b64_tr_b16 a[18:19], v111 offset:4416
    v_mfma_f32_32x32x16_bf16 v[64:79], v[84:87], a[4:7], 0
    ds_read_b128 v[84:87], v118 offset:25472
    v_mfma_f32_16x16x32_bf16 v[4:7], v[96:99], v[104:107], 0
    ds_read_b64_tr_b16 v[104:105], v109 offset:1072
    ds_read_b64_tr_b16 v[106:107], v109 offset:1328
    s_waitcnt lgkmcnt(7)
    v_mfma_f32_32x32x16_bf16 v[16:31], v[88:91], a[8:11], v[16:31]
    s_waitcnt vmcnt(10)
    ds_read_b64_tr_b16 a[20:21], v111 offset:5200
    ds_read_b64_tr_b16 a[22:23], v111 offset:5456
    s_mov_b32 s96, 0x18100
    s_mov_b32 m0, s29
    s_nop 0
    buffer_load_dwordx4 v110, s[8:11], s96 offen lds
    v_mfma_f32_32x32x16_bf16 v[32:47], v[88:91], a[12:15], v[32:47]
    ds_read_b128 v[88:91], v118 offset:8864
    s_waitcnt vmcnt(10)
    ds_read_b64_tr_b16 a[28:29], v111 offset:7280
    ds_read_b64_tr_b16 a[30:31], v111 offset:7536
    s_waitcnt lgkmcnt(8)
    v_mfma_f32_16x16x32_bf16 v[8:11], v[96:99], v[100:103], 0
    ds_read_b64_tr_b16 v[100:101], v109 offset:4160
    ds_read_b64_tr_b16 v[102:103], v109 offset:4416
    v_mfma_f32_32x32x16_bf16 v[48:63], v[92:95], a[8:11], v[48:63]
    ds_read_b64_tr_b16 a[24:25], v111 offset:6240
    ds_read_b64_tr_b16 a[26:27], v111 offset:6496
    s_add_u32 m0, s29, 0x820
    s_nop 0
    buffer_load_dwordx4 v117, s[8:11], s96 offen lds
    v_mfma_f32_32x32x16_bf16 v[64:79], v[92:95], a[12:15], v[64:79]
    ds_read_b128 v[92:95], v118 offset:25504
    s_waitcnt lgkmcnt(8)
    v_mfma_f32_16x16x32_bf16 v[12:15], v[96:99], v[104:107], 0
    ds_read_b64_tr_b16 v[104:105], v109 offset:4192
    ds_read_b64_tr_b16 v[106:107], v109 offset:4448
    v_mfma_f32_32x32x16_bf16 v[16:31], v[80:83], a[16:19], v[16:31]
    ds_read_b128 v[96:99], v108 offset:2080
    s_add_u32 m0, s29, 0x210
    s_nop 0
    buffer_load_dwordx4 v110, s[8:11], s96 offen offset:512 lds
    v_mfma_f32_32x32x16_bf16 v[32:47], v[80:83], a[20:23], v[32:47]
    ds_read_b128 v[80:83], v118 offset:12480
    s_waitcnt lgkmcnt(5)
    v_mfma_f32_16x16x32_bf16 v[0:3], v[122:125], v[100:103], v[0:3]
    ds_read_b64_tr_b16 v[100:101], v109 offset:5200
    ds_read_b64_tr_b16 v[102:103], v109 offset:5456
    v_mfma_f32_32x32x16_bf16 v[48:63], v[84:87], a[16:19], v[48:63]
    v_add_u32 v111, s94, v111
    s_waitcnt vmcnt(11)
    ds_read_b64_tr_b16 a[32:33], v111
    ds_read_b64_tr_b16 a[34:35], v111 offset:256
    s_add_u32 m0, s29, 0xa30
    s_nop 0
    buffer_load_dwordx4 v117, s[8:11], s96 offen offset:512 lds
    v_mfma_f32_32x32x16_bf16 v[64:79], v[84:87], a[20:23], v[64:79]
    ds_read_b128 v[84:87], v118 offset:29120
    s_waitcnt lgkmcnt(6)
    v_mfma_f32_16x16x32_bf16 v[4:7], v[122:125], v[104:107], v[4:7]
    ds_read_b64_tr_b16 v[104:105], v109 offset:5232
    ds_read_b64_tr_b16 v[106:107], v109 offset:5488
    v_mfma_f32_32x32x16_bf16 v[16:31], v[88:91], a[24:27], v[16:31]
    v_add_u32 v109, s94, v109
    s_waitcnt vmcnt(10)
    ds_read_b64_tr_b16 a[36:37], v111 offset:1040
    ds_read_b64_tr_b16 a[38:39], v111 offset:1296
    s_mov_b32 s96, 0x20100
    s_add_u32 m0, s29, 0x1040
    s_nop 0
    buffer_load_dwordx4 v110, s[8:11], s96 offen lds
    v_mfma_f32_32x32x16_bf16 v[32:47], v[88:91], a[28:31], v[32:47]
    ds_read_b128 v[88:91], v118 offset:12512
    s_waitcnt vmcnt(10)
    ds_read_b64_tr_b16 a[44:45], v111 offset:3120
    ds_read_b64_tr_b16 a[46:47], v111 offset:3376
    s_waitcnt lgkmcnt(8)
    v_mfma_f32_16x16x32_bf16 v[8:11], v[122:125], v[100:103], v[8:11]
    ds_read_b64_tr_b16 v[100:101], v109
    ds_read_b64_tr_b16 v[102:103], v109 offset:256
    v_mfma_f32_32x32x16_bf16 v[48:63], v[92:95], a[24:27], v[48:63]
    ds_read_b64_tr_b16 a[40:41], v111 offset:2080
    ds_read_b64_tr_b16 a[42:43], v111 offset:2336
    s_add_u32 m0, s29, 0x1860
    s_nop 0
    buffer_load_dwordx4 v117, s[8:11], s96 offen lds
    v_mfma_f32_32x32x16_bf16 v[64:79], v[92:95], a[28:31], v[64:79]
    ds_read_b128 v[92:95], v118 offset:29152
    s_waitcnt lgkmcnt(8)
    v_mfma_f32_16x16x32_bf16 v[12:15], v[122:125], v[104:107], v[12:15]
    ds_read_b64_tr_b16 v[104:105], v109 offset:32
    ds_read_b64_tr_b16 v[106:107], v109 offset:288
    v_mfma_f32_32x32x16_bf16 v[16:31], v[80:83], a[32:35], v[16:31]
    ds_read_b128 v[122:125], v108 offset:2592
    s_add_u32 m0, s29, 0x1250
    s_nop 0
    buffer_load_dwordx4 v110, s[8:11], s96 offen offset:512 lds
    v_mfma_f32_32x32x16_bf16 v[32:47], v[80:83], a[36:39], v[32:47]
    ds_read_b128 v[80:83], v118 offset:12992
    s_waitcnt lgkmcnt(5)
    v_mfma_f32_16x16x32_bf16 v[0:3], v[96:99], v[100:103], v[0:3]
    ds_read_b64_tr_b16 v[100:101], v109 offset:1040
    ds_read_b64_tr_b16 v[102:103], v109 offset:1296
    v_mfma_f32_32x32x16_bf16 v[48:63], v[84:87], a[32:35], v[48:63]
    v_subrev_u32 v111, s94, v111
    s_waitcnt vmcnt(6)
    ds_read_b64_tr_b16 a[48:49], v111
    ds_read_b64_tr_b16 a[50:51], v111 offset:256
    s_add_u32 m0, s29, 0x1a70
    s_nop 0
    buffer_load_dwordx4 v117, s[8:11], s96 offen offset:512 lds
    v_mfma_f32_32x32x16_bf16 v[64:79], v[84:87], a[36:39], v[64:79]
    ds_read_b128 v[84:87], v118 offset:29632
    s_waitcnt lgkmcnt(6)
    v_mfma_f32_16x16x32_bf16 v[4:7], v[96:99], v[104:107], v[4:7]
    ds_read_b64_tr_b16 v[104:105], v109 offset:1072
    ds_read_b64_tr_b16 v[106:107], v109 offset:1328
    v_mfma_f32_32x32x16_bf16 v[16:31], v[88:91], a[40:43], v[16:31]
    v_subrev_u32 v109, s94, v109
    s_waitcnt vmcnt(5)
    ds_read_b64_tr_b16 a[52:53], v111 offset:1040
    ds_read_b64_tr_b16 a[54:55], v111 offset:1296
    s_mov_b32 s96, 0x28100
    s_mov_b32 m0, s41
    s_nop 0
    buffer_load_dwordx4 v110, s[8:11], s96 offen lds
    v_mfma_f32_32x32x16_bf16 v[32:47], v[88:91], a[44:47], v[32:47]
    ds_read_b128 v[88:91], v118 offset:13024
    s_waitcnt vmcnt(5)
    ds_read_b64_tr_b16 a[60:61], v111 offset:3120
    ds_read_b64_tr_b16 a[62:63], v111 offset:3376
    s_waitcnt lgkmcnt(8)
    v_mfma_f32_16x16x32_bf16 v[8:11], v[96:99], v[100:103], v[8:11]
    ds_read_b64_tr_b16 v[100:101], v109
    ds_read_b64_tr_b16 v[102:103], v109 offset:256
    v_mfma_f32_32x32x16_bf16 v[48:63], v[92:95], a[40:43], v[48:63]
    ds_read_b64_tr_b16 a[56:57], v111 offset:2080
    ds_read_b64_tr_b16 a[58:59], v111 offset:2336
    s_add_u32 m0, s41, 0x820
    s_nop 0
    buffer_load_dwordx4 v117, s[8:11], s96 offen lds
    v_mfma_f32_32x32x16_bf16 v[64:79], v[92:95], a[44:47], v[64:79]
    ds_read_b128 v[92:95], v118 offset:29664
    s_waitcnt lgkmcnt(8)
    v_mfma_f32_16x16x32_bf16 v[12:15], v[96:99], v[104:107], v[12:15]
    ds_read_b64_tr_b16 v[104:105], v109 offset:32
    ds_read_b64_tr_b16 v[106:107], v109 offset:288
    v_mfma_f32_32x32x16_bf16 v[16:31], v[80:83], a[48:51], v[16:31]
    ds_read_b128 v[96:99], v108 offset:4160
    s_add_u32 m0, s41, 0x210
    s_nop 0
    buffer_load_dwordx4 v110, s[8:11], s96 offen offset:512 lds
    v_mfma_f32_32x32x16_bf16 v[32:47], v[80:83], a[52:55], v[32:47]
    ds_read_b128 v[80:83], v118 offset:16640
    s_waitcnt lgkmcnt(5)
    v_mfma_f32_16x16x32_bf16 v[0:3], v[122:125], v[100:103], v[0:3]
    ds_read_b64_tr_b16 v[100:101], v109 offset:1040
    ds_read_b64_tr_b16 v[102:103], v109 offset:1296
    v_mfma_f32_32x32x16_bf16 v[48:63], v[84:87], a[48:51], v[48:63]
    s_waitcnt vmcnt(6)
    ds_read_b64_tr_b16 a[64:65], v111 offset:4160
    ds_read_b64_tr_b16 a[66:67], v111 offset:4416
    s_add_u32 m0, s41, 0xa30
    s_nop 0
    buffer_load_dwordx4 v117, s[8:11], s96 offen offset:512 lds
    v_mfma_f32_32x32x16_bf16 v[64:79], v[84:87], a[52:55], v[64:79]
    ds_read_b128 v[84:87], v118 offset:33280
    s_waitcnt lgkmcnt(6)
    v_mfma_f32_16x16x32_bf16 v[4:7], v[122:125], v[104:107], v[4:7]
    ds_read_b64_tr_b16 v[104:105], v109 offset:1072
    ds_read_b64_tr_b16 v[106:107], v109 offset:1328
    v_mfma_f32_32x32x16_bf16 v[16:31], v[88:91], a[56:59], v[16:31]
    s_waitcnt vmcnt(5)
    ds_read_b64_tr_b16 a[68:69], v111 offset:5200
    ds_read_b64_tr_b16 a[70:71], v111 offset:5456
    s_mov_b32 s96, 0x30100
    s_mov_b32 m0, s29
    s_nop 0
    buffer_load_dwordx4 v110, s[8:11], s96 offen lds
    v_mfma_f32_32x32x16_bf16 v[32:47], v[88:91], a[60:63], v[32:47]
    ds_read_b128 v[88:91], v118 offset:16672
    s_waitcnt vmcnt(5)
    ds_read_b64_tr_b16 a[76:77], v111 offset:7280
    ds_read_b64_tr_b16 a[78:79], v111 offset:7536
    s_waitcnt lgkmcnt(8)
    v_mfma_f32_16x16x32_bf16 v[8:11], v[122:125], v[100:103], v[8:11]
    ds_read_b64_tr_b16 v[100:101], v109 offset:4160
    ds_read_b64_tr_b16 v[102:103], v109 offset:4416
    v_mfma_f32_32x32x16_bf16 v[48:63], v[92:95], a[56:59], v[48:63]
    ds_read_b64_tr_b16 a[72:73], v111 offset:6240
    ds_read_b64_tr_b16 a[74:75], v111 offset:6496
    s_add_u32 m0, s29, 0x820
    s_nop 0
    buffer_load_dwordx4 v117, s[8:11], s96 offen lds
    v_mfma_f32_32x32x16_bf16 v[64:79], v[92:95], a[60:63], v[64:79]
    ds_read_b128 v[92:95], v118 offset:33312
    s_waitcnt lgkmcnt(8)
    v_mfma_f32_16x16x32_bf16 v[12:15], v[122:125], v[104:107], v[12:15]
    ds_read_b64_tr_b16 v[104:105], v109 offset:4192
    ds_read_b64_tr_b16 v[106:107], v109 offset:4448
    v_mfma_f32_32x32x16_bf16 v[16:31], v[80:83], a[64:67], v[16:31]
    ds_read_b128 v[122:125], v108 offset:4672
    s_add_u32 m0, s29, 0x210
    s_nop 0
    buffer_load_dwordx4 v110, s[8:11], s96 offen offset:512 lds
    v_mfma_f32_32x32x16_bf16 v[32:47], v[80:83], a[68:71], v[32:47]
    ds_read_b128 v[80:83], v118 offset:17152
    s_waitcnt lgkmcnt(5)
    v_mfma_f32_16x16x32_bf16 v[0:3], v[96:99], v[100:103], v[0:3]
    ds_read_b64_tr_b16 v[100:101], v109 offset:5200
    ds_read_b64_tr_b16 v[102:103], v109 offset:5456
    v_mfma_f32_32x32x16_bf16 v[48:63], v[84:87], a[64:67], v[48:63]
    v_add_u32 v111, s94, v111
    s_waitcnt vmcnt(6)
    ds_read_b64_tr_b16 a[80:81], v111
    ds_read_b64_tr_b16 a[82:83], v111 offset:256
    s_add_u32 m0, s29, 0xa30
    s_nop 0
    buffer_load_dwordx4 v117, s[8:11], s96 offen offset:512 lds
    v_mfma_f32_32x32x16_bf16 v[64:79], v[84:87], a[68:71], v[64:79]
    ds_read_b128 v[84:87], v118 offset:33792
    s_waitcnt lgkmcnt(6)
    v_mfma_f32_16x16x32_bf16 v[4:7], v[96:99], v[104:107], v[4:7]
    ds_read_b64_tr_b16 v[104:105], v109 offset:5232
    ds_read_b64_tr_b16 v[106:107], v109 offset:5488
    v_mfma_f32_32x32x16_bf16 v[16:31], v[88:91], a[72:75], v[16:31]
    v_add_u32 v109, s94, v109
    s_waitcnt vmcnt(5)
    ds_read_b64_tr_b16 a[84:85], v111 offset:1040
    ds_read_b64_tr_b16 a[86:87], v111 offset:1296
    s_mov_b32 s96, 0x38100
    s_add_u32 m0, s29, 0x1040
    s_nop 0
    buffer_load_dwordx4 v110, s[8:11], s96 offen lds
    v_mfma_f32_32x32x16_bf16 v[32:47], v[88:91], a[76:79], v[32:47]
    ds_read_b128 v[88:91], v118 offset:17184
    s_waitcnt vmcnt(5)
    ds_read_b64_tr_b16 a[92:93], v111 offset:3120
    ds_read_b64_tr_b16 a[94:95], v111 offset:3376
    s_waitcnt lgkmcnt(8)
    v_mfma_f32_16x16x32_bf16 v[8:11], v[96:99], v[100:103], v[8:11]
    ds_read_b64_tr_b16 v[100:101], v109
    ds_read_b64_tr_b16 v[102:103], v109 offset:256
    v_mfma_f32_32x32x16_bf16 v[48:63], v[92:95], a[72:75], v[48:63]
    ds_read_b64_tr_b16 a[88:89], v111 offset:2080
    ds_read_b64_tr_b16 a[90:91], v111 offset:2336
    s_add_u32 m0, s29, 0x1860
    s_nop 0
    buffer_load_dwordx4 v117, s[8:11], s96 offen lds
    v_mfma_f32_32x32x16_bf16 v[64:79], v[92:95], a[76:79], v[64:79]
    ds_read_b128 v[92:95], v118 offset:33824
    s_waitcnt lgkmcnt(8)
    v_mfma_f32_16x16x32_bf16 v[12:15], v[96:99], v[104:107], v[12:15]
    ds_read_b64_tr_b16 v[104:105], v109 offset:32
    ds_read_b64_tr_b16 v[106:107], v109 offset:288
    v_mfma_f32_32x32x16_bf16 v[16:31], v[80:83], a[80:83], v[16:31]
    ds_read_b128 v[96:99], v108 offset:6240
    s_add_u32 m0, s29, 0x1250
    s_nop 0
    buffer_load_dwordx4 v110, s[8:11], s96 offen offset:512 lds
    v_mfma_f32_32x32x16_bf16 v[32:47], v[80:83], a[84:87], v[32:47]
    ds_read_b128 v[80:83], v118 offset:20800
    s_waitcnt lgkmcnt(5)
    v_mfma_f32_16x16x32_bf16 v[0:3], v[122:125], v[100:103], v[0:3]
    ds_read_b64_tr_b16 v[100:101], v109 offset:1040
    ds_read_b64_tr_b16 v[102:103], v109 offset:1296
    v_mfma_f32_32x32x16_bf16 v[48:63], v[84:87], a[80:83], v[48:63]
    v_subrev_u32 v111, s94, v111
    s_waitcnt vmcnt(6)
    ds_read_b64_tr_b16 a[96:97], v111
    ds_read_b64_tr_b16 a[98:99], v111 offset:256
    s_add_u32 m0, s29, 0x1a70
    s_nop 0
    buffer_load_dwordx4 v117, s[8:11], s96 offen offset:512 lds
    v_mfma_f32_32x32x16_bf16 v[64:79], v[84:87], a[84:87], v[64:79]
    ds_read_b128 v[84:87], v118 offset:37440
    s_waitcnt lgkmcnt(6)
    v_mfma_f32_16x16x32_bf16 v[4:7], v[122:125], v[104:107], v[4:7]
    ds_read_b64_tr_b16 v[104:105], v109 offset:1072
    ds_read_b64_tr_b16 v[106:107], v109 offset:1328
    v_mfma_f32_32x32x16_bf16 v[16:31], v[88:91], a[88:91], v[16:31]
    v_subrev_u32 v109, s94, v109
    s_waitcnt vmcnt(5)
    ds_read_b64_tr_b16 a[100:101], v111 offset:1040
    ds_read_b64_tr_b16 a[102:103], v111 offset:1296
    v_mfma_f32_32x32x16_bf16 v[32:47], v[88:91], a[92:95], v[32:47]
    ds_read_b128 v[88:91], v118 offset:20832
    s_waitcnt vmcnt(4)
    ds_read_b64_tr_b16 a[108:109], v111 offset:3120
    ds_read_b64_tr_b16 a[110:111], v111 offset:3376
    s_waitcnt lgkmcnt(8)
    v_mfma_f32_16x16x32_bf16 v[8:11], v[122:125], v[100:103], v[8:11]
    ds_read_b64_tr_b16 v[100:101], v109
    ds_read_b64_tr_b16 v[102:103], v109 offset:256
    v_mfma_f32_32x32x16_bf16 v[48:63], v[92:95], a[88:91], v[48:63]
    ds_read_b64_tr_b16 a[104:105], v111 offset:2080
    ds_read_b64_tr_b16 a[106:107], v111 offset:2336
    s_mov_b32 m0, s41
    s_add_u32 s30, s37, 0xd000
    s_waitcnt lgkmcnt(9)
    buffer_load_dwordx4 v116, s[4:7], s30 offen lds
    v_mfma_f32_32x32x16_bf16 v[64:79], v[92:95], a[92:95], v[64:79]
    ds_read_b128 v[92:95], v118 offset:37472
    v_mfma_f32_16x16x32_bf16 v[12:15], v[122:125], v[104:107], v[12:15]
    ds_read_b64_tr_b16 v[104:105], v109 offset:32
    ds_read_b64_tr_b16 v[106:107], v109 offset:288
    v_mfma_f32_32x32x16_bf16 v[16:31], v[80:83], a[96:99], v[16:31]
    ds_read_b128 v[122:125], v108 offset:6752
    s_add_u32 m0, s41, 0x410
    s_add_u32 s30, s37, 0xe000
    buffer_load_dwordx4 v116, s[4:7], s30 offen lds
    s_waitcnt lgkmcnt(6)
    v_mfma_f32_32x32x16_bf16 v[32:47], v[80:83], a[100:103], v[32:47]
    ds_read_b128 v[80:83], v118 offset:21312
    v_mfma_f32_16x16x32_bf16 v[0:3], v[96:99], v[100:103], v[0:3]
    ds_read_b64_tr_b16 v[100:101], v109 offset:1040
    ds_read_b64_tr_b16 v[102:103], v109 offset:1296
    v_mfma_f32_32x32x16_bf16 v[48:63], v[84:87], a[96:99], v[48:63]
    s_waitcnt vmcnt(5)
    ds_read_b64_tr_b16 a[112:113], v111 offset:4160
    ds_read_b64_tr_b16 a[114:115], v111 offset:4416
    s_add_u32 m0, s41, 0x820
    s_add_u32 s30, s37, 0xf000
    buffer_load_dwordx4 v116, s[4:7], s30 offen lds
    v_mfma_f32_32x32x16_bf16 v[64:79], v[84:87], a[100:103], v[64:79]
    ds_read_b128 v[84:87], v118 offset:37952
    s_waitcnt lgkmcnt(6)
    v_mfma_f32_16x16x32_bf16 v[4:7], v[96:99], v[104:107], v[4:7]
    ds_read_b64_tr_b16 v[104:105], v109 offset:1072
    ds_read_b64_tr_b16 v[106:107], v109 offset:1328
    v_mfma_f32_32x32x16_bf16 v[16:31], v[88:91], a[104:107], v[16:31]
    s_waitcnt vmcnt(4)
    ds_read_b64_tr_b16 a[116:117], v111 offset:5200
    ds_read_b64_tr_b16 a[118:119], v111 offset:5456
    s_add_u32 m0, s41, 0xc30
    s_add_u32 s30, s37, 0x10000
    buffer_load_dwordx4 v116, s[4:7], s30 offen lds
    v_mfma_f32_32x32x16_bf16 v[32:47], v[88:91], a[108:111], v[32:47]
    ds_read_b128 v[88:91], v118 offset:21344
    s_waitcnt vmcnt(4)
    ds_read_b64_tr_b16 a[124:125], v111 offset:7280
    ds_read_b64_tr_b16 a[126:127], v111 offset:7536
    s_waitcnt lgkmcnt(8)
    v_mfma_f32_16x16x32_bf16 v[8:11], v[96:99], v[100:103], v[8:11]
    ds_read_b64_tr_b16 v[100:101], v109 offset:4160
    ds_read_b64_tr_b16 v[102:103], v109 offset:4416
    v_mfma_f32_32x32x16_bf16 v[48:63], v[92:95], a[104:107], v[48:63]
    ds_read_b64_tr_b16 a[120:121], v111 offset:6240
    ds_read_b64_tr_b16 a[122:123], v111 offset:6496
    v_mfma_f32_32x32x16_bf16 v[64:79], v[92:95], a[108:111], v[64:79]
    ds_read_b128 v[92:95], v118 offset:37984
    s_waitcnt lgkmcnt(8)
    v_mfma_f32_16x16x32_bf16 v[12:15], v[96:99], v[104:107], v[12:15]
    ds_read_b64_tr_b16 v[104:105], v109 offset:4192
    ds_read_b64_tr_b16 v[106:107], v109 offset:4448
    v_mfma_f32_32x32x16_bf16 v[16:31], v[80:83], a[112:115], v[16:31]
    v_mfma_f32_32x32x16_bf16 v[32:47], v[80:83], a[116:119], v[32:47]
    s_waitcnt lgkmcnt(3)
    v_mfma_f32_16x16x32_bf16 v[0:3], v[122:125], v[100:103], v[0:3]
    ds_read_b64_tr_b16 v[100:101], v109 offset:5200
    ds_read_b64_tr_b16 v[102:103], v109 offset:5456
    v_mfma_f32_32x32x16_bf16 v[48:63], v[84:87], a[112:115], v[48:63]
    v_mfma_f32_32x32x16_bf16 v[64:79], v[84:87], a[116:119], v[64:79]
    s_waitcnt lgkmcnt(2)
    v_mfma_f32_16x16x32_bf16 v[4:7], v[122:125], v[104:107], v[4:7]
    ds_read_b64_tr_b16 v[104:105], v109 offset:5232
    ds_read_b64_tr_b16 v[106:107], v109 offset:5488
    v_mfma_f32_32x32x16_bf16 v[16:31], v[88:91], a[120:123], v[16:31]
    v_mfma_f32_32x32x16_bf16 v[32:47], v[88:91], a[124:127], v[32:47]
    s_waitcnt lgkmcnt(2)
    v_mfma_f32_16x16x32_bf16 v[8:11], v[122:125], v[100:103], v[8:11]
    v_mfma_f32_32x32x16_bf16 v[48:63], v[92:95], a[120:123], v[48:63]
    v_mfma_f32_32x32x16_bf16 v[64:79], v[92:95], a[124:127], v[64:79]
    s_waitcnt lgkmcnt(0)
    v_mfma_f32_16x16x32_bf16 v[12:15], v[122:125], v[104:107], v[12:15]
    s_waitcnt vmcnt(0)
    s_barrier
    s_setprio 1
    v_and_b32 v95, -4, v112
    v_and_b32 v93, 2, v112
    v_mov_b32 v94, v113
    v_mul_f32 v8, s32, v8
    v_mul_f32 v9, s32, v9
    v_mul_f32 v10, s32, v10
    v_mul_f32 v11, s32, v11
    v_exp_f32 v8, v8
    ds_read2_b32 v[108:109], v95 offset0:0 offset1:1
    ds_read2_b32 v[110:111], v95 offset0:2 offset1:3
    ds_read2_b32 v[112:113], v95 offset0:4 offset1:5
    ds_read2_b32 v[114:115], v95 offset0:6 offset1:7
    v_exp_f32 v9, v9
    ds_read2_b32 v[116:117], v95 offset0:8 offset1:9
    ds_read2_b32 v[96:97], v95 offset0:160 offset1:161
    ds_read2_b32 v[98:99], v95 offset0:162 offset1:163
    ds_read2_b32 v[100:101], v95 offset0:164 offset1:165
    v_exp_f32 v10, v10
    ds_read2_b32 v[102:103], v95 offset0:166 offset1:167
    ds_read2_b32 v[104:105], v95 offset0:168 offset1:169
    ds_read_b32 v91, v95 offset:40
    ds_read_b32 v92, v95 offset:680
    v_exp_f32 v11, v11
    v_fma_f32 v8, v8, s33, s33
    v_fma_f32 v9, v9, s33, s33
    v_fma_f32 v10, v10, s33, s33
    v_fma_f32 v11, v11, s33, s33
    v_rcp_f32 v8, v8
    v_rcp_f32 v9, v9
    v_rcp_f32 v10, v10
    v_rcp_f32 v11, v11
    v_mul_f32 v0, v0, v8
    v_mul_f32 v1, v1, v9
    v_mul_f32 v2, v2, v10
    v_mul_f32 v3, v3, v11
    v_cvt_pk_bf16_f32 v8, v0, v1
    v_cvt_pk_bf16_f32 v9, v2, v3
    ds_write_b64 v94, v[8:9]
    v_mul_f32 v12, s32, v12
    v_mul_f32 v13, s32, v13
    v_mul_f32 v14, s32, v14
    v_mul_f32 v15, s32, v15
    v_exp_f32 v12, v12
    v_exp_f32 v13, v13
    v_exp_f32 v14, v14
    v_exp_f32 v15, v15
    v_fma_f32 v12, v12, s33, s33
    v_fma_f32 v13, v13, s33, s33
    v_fma_f32 v14, v14, s33, s33
    v_fma_f32 v15, v15, s33, s33
    v_rcp_f32 v12, v12
    v_rcp_f32 v13, v13
    v_rcp_f32 v14, v14
    v_rcp_f32 v15, v15
    v_mul_f32 v4, v4, v12
    v_mul_f32 v5, v5, v13
    v_mul_f32 v6, v6, v14
    v_mul_f32 v7, v7, v15
    v_cvt_pk_bf16_f32 v10, v4, v5
    v_cvt_pk_bf16_f32 v11, v6, v7
    ds_write_b64 v94, v[10:11] offset:2816
    v_mul_f32 v32, s32, v32
    v_mul_f32 v33, s32, v33
    v_mul_f32 v34, s32, v34
    v_mul_f32 v35, s32, v35
    v_exp_f32 v32, v32
    v_exp_f32 v33, v33
    v_exp_f32 v34, v34
    v_exp_f32 v35, v35
    v_fma_f32 v32, v32, s33, s33
    v_fma_f32 v33, v33, s33, s33
    v_fma_f32 v34, v34, s33, s33
    v_fma_f32 v35, v35, s33, s33
    v_rcp_f32 v32, v32
    v_rcp_f32 v33, v33
    v_rcp_f32 v34, v34
    v_rcp_f32 v35, v35
    v_mul_f32 v16, v16, v32
    v_mul_f32 v17, v17, v33
    v_mul_f32 v18, v18, v34
    v_mul_f32 v19, v19, v35
    v_cvt_pk_bf16_f32 v32, v16, v17
    v_cvt_pk_bf16_f32 v33, v18, v19
    v_mul_f32 v36, s32, v36
    v_mul_f32 v37, s32, v37
    v_mul_f32 v38, s32, v38
    v_mul_f32 v39, s32, v39
    v_exp_f32 v36, v36
    v_exp_f32 v37, v37
    v_exp_f32 v38, v38
    v_exp_f32 v39, v39
    v_fma_f32 v36, v36, s33, s33
    v_fma_f32 v37, v37, s33, s33
    v_fma_f32 v38, v38, s33, s33
    v_fma_f32 v39, v39, s33, s33
    v_rcp_f32 v36, v36
    v_rcp_f32 v37, v37
    v_rcp_f32 v38, v38
    v_rcp_f32 v39, v39
    v_mul_f32 v20, v20, v36
    v_mul_f32 v21, v21, v37
    v_mul_f32 v22, v22, v38
    v_mul_f32 v23, v23, v39
    v_cvt_pk_bf16_f32 v34, v20, v21
    v_cvt_pk_bf16_f32 v35, v22, v23
    ds_write_b128 v119, v[32:35] offset:32
    v_mul_f32 v40, s32, v40
    v_mul_f32 v41, s32, v41
    v_mul_f32 v42, s32, v42
    v_mul_f32 v43, s32, v43
    v_exp_f32 v40, v40
    v_exp_f32 v41, v41
    v_exp_f32 v42, v42
    v_exp_f32 v43, v43
    v_fma_f32 v40, v40, s33, s33
    v_fma_f32 v41, v41, s33, s33
    v_fma_f32 v42, v42, s33, s33
    v_fma_f32 v43, v43, s33, s33
    v_rcp_f32 v40, v40
    v_rcp_f32 v41, v41
    v_rcp_f32 v42, v42
    v_rcp_f32 v43, v43
    v_mul_f32 v24, v24, v40
    v_mul_f32 v25, v25, v41
    v_mul_f32 v26, v26, v42
    v_mul_f32 v27, v27, v43
    v_cvt_pk_bf16_f32 v36, v24, v25
    v_cvt_pk_bf16_f32 v37, v26, v27
    v_mul_f32 v44, s32, v44
    v_mul_f32 v45, s32, v45
    v_mul_f32 v46, s32, v46
    v_mul_f32 v47, s32, v47
    v_exp_f32 v44, v44
    v_exp_f32 v45, v45
    v_exp_f32 v46, v46
    v_exp_f32 v47, v47
    v_fma_f32 v44, v44, s33, s33
    v_fma_f32 v45, v45, s33, s33
    v_fma_f32 v46, v46, s33, s33
    v_fma_f32 v47, v47, s33, s33
    v_rcp_f32 v44, v44
    v_rcp_f32 v45, v45
    v_rcp_f32 v46, v46
    v_rcp_f32 v47, v47
    v_mul_f32 v28, v28, v44
    v_mul_f32 v29, v29, v45
    v_mul_f32 v30, v30, v46
    v_mul_f32 v31, v31, v47
    v_cvt_pk_bf16_f32 v38, v28, v29
    v_cvt_pk_bf16_f32 v39, v30, v31
    ds_write_b128 v119, v[36:39] offset:48
    ds_read_b128 v[16:19], v120 offset:32
    ds_read_b128 v[28:31], v120 offset:2848
    ds_read_b128 v[20:23], v120 offset:48
    ds_read_b128 v[40:43], v120 offset:2864
    ds_read_b128 v[24:27], v120 offset:64
    ds_read_b128 v[44:47], v120 offset:2880
    v_mul_f32 v64, s32, v64
    v_mul_f32 v65, s32, v65
    v_mul_f32 v66, s32, v66
    v_mul_f32 v67, s32, v67
    v_exp_f32 v64, v64
    v_exp_f32 v65, v65
    v_exp_f32 v66, v66
    v_exp_f32 v67, v67
    v_fma_f32 v64, v64, s33, s33
    v_fma_f32 v65, v65, s33, s33
    v_fma_f32 v66, v66, s33, s33
    v_fma_f32 v67, v67, s33, s33
    v_rcp_f32 v64, v64
    v_rcp_f32 v65, v65
    v_rcp_f32 v66, v66
    v_rcp_f32 v67, v67
    v_mul_f32 v48, v48, v64
    v_mul_f32 v49, v49, v65
    v_mul_f32 v50, v50, v66
    v_mul_f32 v51, v51, v67
    v_cvt_pk_bf16_f32 v64, v48, v49
    v_cvt_pk_bf16_f32 v65, v50, v51
    v_mul_f32 v68, s32, v68
    v_mul_f32 v69, s32, v69
    v_mul_f32 v70, s32, v70
    v_mul_f32 v71, s32, v71
    v_exp_f32 v68, v68
    v_exp_f32 v69, v69
    v_exp_f32 v70, v70
    v_exp_f32 v71, v71
    v_fma_f32 v68, v68, s33, s33
    v_fma_f32 v69, v69, s33, s33
    v_fma_f32 v70, v70, s33, s33
    v_fma_f32 v71, v71, s33, s33
    v_rcp_f32 v68, v68
    v_rcp_f32 v69, v69
    v_rcp_f32 v70, v70
    v_rcp_f32 v71, v71
    v_mul_f32 v52, v52, v68
    v_mul_f32 v53, v53, v69
    v_mul_f32 v54, v54, v70
    v_mul_f32 v55, v55, v71
    v_cvt_pk_bf16_f32 v66, v52, v53
    v_cvt_pk_bf16_f32 v67, v54, v55
    ds_write_b128 v119, v[64:67] offset:96
    v_mul_f32 v72, s32, v72
    v_mul_f32 v73, s32, v73
    v_mul_f32 v74, s32, v74
    v_mul_f32 v75, s32, v75
    v_exp_f32 v72, v72
    v_exp_f32 v73, v73
    v_exp_f32 v74, v74
    v_exp_f32 v75, v75
    v_fma_f32 v72, v72, s33, s33
    v_fma_f32 v73, v73, s33, s33
    v_fma_f32 v74, v74, s33, s33
    v_fma_f32 v75, v75, s33, s33
    v_rcp_f32 v72, v72
    v_rcp_f32 v73, v73
    v_rcp_f32 v74, v74
    v_rcp_f32 v75, v75
    v_mul_f32 v56, v56, v72
    v_mul_f32 v57, v57, v73
    v_mul_f32 v58, v58, v74
    v_mul_f32 v59, v59, v75
    v_cvt_pk_bf16_f32 v68, v56, v57
    v_cvt_pk_bf16_f32 v69, v58, v59
    v_mul_f32 v76, s32, v76
    v_mul_f32 v77, s32, v77
    v_mul_f32 v78, s32, v78
    v_mul_f32 v79, s32, v79
    v_exp_f32 v76, v76
    v_exp_f32 v77, v77
    v_exp_f32 v78, v78
    v_exp_f32 v79, v79
    v_fma_f32 v76, v76, s33, s33
    v_fma_f32 v77, v77, s33, s33
    v_fma_f32 v78, v78, s33, s33
    v_fma_f32 v79, v79, s33, s33
    v_rcp_f32 v76, v76
    v_rcp_f32 v77, v77
    v_rcp_f32 v78, v78
    v_rcp_f32 v79, v79
    v_mul_f32 v60, v60, v76
    v_mul_f32 v61, v61, v77
    v_mul_f32 v62, v62, v78
    v_mul_f32 v63, v63, v79
    v_cvt_pk_bf16_f32 v70, v60, v61
    v_cvt_pk_bf16_f32 v71, v62, v63
    ds_write_b128 v119, v[68:71] offset:112
    s_waitcnt lgkmcnt(1)
    v_alignbyte_b32 v108, v109, v108, v93
    v_alignbyte_b32 v109, v110, v109, v93
    v_alignbyte_b32 v110, v111, v110, v93
    v_alignbyte_b32 v111, v112, v111, v93
    v_alignbyte_b32 v112, v113, v112, v93
    v_alignbyte_b32 v113, v114, v113, v93
    v_alignbyte_b32 v114, v115, v114, v93
    v_alignbyte_b32 v115, v116, v115, v93
    v_alignbyte_b32 v116, v117, v116, v93
    v_alignbyte_b32 v117, v91, v117, v93
    v_alignbyte_b32 v96, v97, v96, v93
    v_alignbyte_b32 v97, v98, v97, v93
    v_alignbyte_b32 v98, v99, v98, v93
    v_alignbyte_b32 v99, v100, v99, v93
    v_alignbyte_b32 v100, v101, v100, v93
    v_alignbyte_b32 v101, v102, v101, v93
    v_alignbyte_b32 v102, v103, v102, v93
    v_alignbyte_b32 v103, v104, v103, v93
    v_alignbyte_b32 v104, v105, v104, v93
    v_alignbyte_b32 v105, v92, v105, v93
    s_setprio 3
    v_mfma_f32_4x4x4_16b_bf16 v[0:3], v[108:109], v[16:17], 0
    v_mfma_f32_4x4x4_16b_bf16 v[4:7], v[108:109], v[18:19], 0
    v_mfma_f32_4x4x4_16b_bf16 v[8:11], v[96:97], v[28:29], 0
    v_mfma_f32_4x4x4_16b_bf16 v[12:15], v[96:97], v[30:31], 0
    v_mfma_f32_4x4x4_16b_bf16 v[0:3], v[110:111], v[18:19], v[0:3]
    v_mfma_f32_4x4x4_16b_bf16 v[4:7], v[110:111], v[20:21], v[4:7]
    v_mfma_f32_4x4x4_16b_bf16 v[8:11], v[98:99], v[30:31], v[8:11]
    v_mfma_f32_4x4x4_16b_bf16 v[12:15], v[98:99], v[40:41], v[12:15]
    v_mfma_f32_4x4x4_16b_bf16 v[0:3], v[112:113], v[20:21], v[0:3]
    v_mfma_f32_4x4x4_16b_bf16 v[4:7], v[112:113], v[22:23], v[4:7]
    v_mfma_f32_4x4x4_16b_bf16 v[8:11], v[100:101], v[40:41], v[8:11]
    v_mfma_f32_4x4x4_16b_bf16 v[12:15], v[100:101], v[42:43], v[12:15]
    v_mfma_f32_4x4x4_16b_bf16 v[0:3], v[114:115], v[22:23], v[0:3]
    v_mfma_f32_4x4x4_16b_bf16 v[4:7], v[114:115], v[24:25], v[4:7]
    v_mfma_f32_4x4x4_16b_bf16 v[8:11], v[102:103], v[42:43], v[8:11]
    v_mfma_f32_4x4x4_16b_bf16 v[12:15], v[102:103], v[44:45], v[12:15]
    v_mfma_f32_4x4x4_16b_bf16 v[0:3], v[116:117], v[24:25], v[0:3]
    v_mfma_f32_4x4x4_16b_bf16 v[4:7], v[116:117], v[26:27], v[4:7]
    v_mfma_f32_4x4x4_16b_bf16 v[8:11], v[104:105], v[44:45], v[8:11]
    v_mfma_f32_4x4x4_16b_bf16 v[12:15], v[104:105], v[46:47], v[12:15]
    s_setprio 1
    ds_read_b128 v[16:19], v120 offset:96
    ds_read_b128 v[28:31], v120 offset:2912
    ds_read_b128 v[20:23], v120 offset:112
    ds_read_b128 v[40:43], v120 offset:2928
    ds_read_b128 v[24:27], v120 offset:128
    ds_read_b128 v[44:47], v120 offset:2944
    v_exp_f32 v32, v0
    v_exp_f32 v33, v1
    v_exp_f32 v34, v2
    v_exp_f32 v35, v3
    v_fma_f32 v32, v32, s32, s32
    v_fma_f32 v33, v33, s32, s32
    v_fma_f32 v34, v34, s32, s32
    v_fma_f32 v35, v35, s32, s32
    v_rcp_f32 v32, v32
    v_rcp_f32 v33, v33
    v_rcp_f32 v34, v34
    v_rcp_f32 v35, v35
    v_mul_f32 v0, v0, v32
    v_mul_f32 v1, v1, v33
    v_mul_f32 v2, v2, v34
    v_mul_f32 v3, v3, v35
    v_cvt_pk_bf16_f32 v0, v0, v1
    v_cvt_pk_bf16_f32 v1, v2, v3
    v_exp_f32 v36, v4
    v_exp_f32 v37, v5
    v_exp_f32 v38, v6
    v_exp_f32 v39, v7
    v_fma_f32 v36, v36, s32, s32
    v_fma_f32 v37, v37, s32, s32
    v_fma_f32 v38, v38, s32, s32
    v_fma_f32 v39, v39, s32, s32
    v_rcp_f32 v36, v36
    v_rcp_f32 v37, v37
    v_rcp_f32 v38, v38
    v_rcp_f32 v39, v39
    v_mul_f32 v4, v4, v36
    v_mul_f32 v5, v5, v37
    v_mul_f32 v6, v6, v38
    v_mul_f32 v7, v7, v39
    v_cvt_pk_bf16_f32 v2, v4, v5
    v_cvt_pk_bf16_f32 v3, v6, v7
    ds_write_b128 v121, v[0:3]
    v_exp_f32 v32, v8
    v_exp_f32 v33, v9
    v_exp_f32 v34, v10
    v_exp_f32 v35, v11
    v_fma_f32 v32, v32, s32, s32
    v_fma_f32 v33, v33, s32, s32
    v_fma_f32 v34, v34, s32, s32
    v_fma_f32 v35, v35, s32, s32
    v_rcp_f32 v32, v32
    v_rcp_f32 v33, v33
    v_rcp_f32 v34, v34
    v_rcp_f32 v35, v35
    v_mul_f32 v8, v8, v32
    v_mul_f32 v9, v9, v33
    v_mul_f32 v10, v10, v34
    v_mul_f32 v11, v11, v35
    v_cvt_pk_bf16_f32 v8, v8, v9
    v_cvt_pk_bf16_f32 v9, v10, v11
    v_exp_f32 v36, v12
    v_exp_f32 v37, v13
    v_exp_f32 v38, v14
    v_exp_f32 v39, v15
    v_fma_f32 v36, v36, s32, s32
    v_fma_f32 v37, v37, s32, s32
    v_fma_f32 v38, v38, s32, s32
    v_fma_f32 v39, v39, s32, s32
    v_rcp_f32 v36, v36
    v_rcp_f32 v37, v37
    v_rcp_f32 v38, v38
    v_rcp_f32 v39, v39
    v_mul_f32 v12, v12, v36
    v_mul_f32 v13, v13, v37
    v_mul_f32 v14, v14, v38
    v_mul_f32 v15, v15, v39
    v_cvt_pk_bf16_f32 v10, v12, v13
    v_cvt_pk_bf16_f32 v11, v14, v15
    ds_write_b128 v121, v[8:11] offset:1024
    s_setprio 3
    s_waitcnt lgkmcnt(1)
    v_mfma_f32_4x4x4_16b_bf16 v[0:3], v[108:109], v[16:17], 0
    v_mfma_f32_4x4x4_16b_bf16 v[4:7], v[108:109], v[18:19], 0
    v_mfma_f32_4x4x4_16b_bf16 v[8:11], v[96:97], v[28:29], 0
    v_mfma_f32_4x4x4_16b_bf16 v[12:15], v[96:97], v[30:31], 0
    v_mfma_f32_4x4x4_16b_bf16 v[0:3], v[110:111], v[18:19], v[0:3]
    v_mfma_f32_4x4x4_16b_bf16 v[4:7], v[110:111], v[20:21], v[4:7]
    v_mfma_f32_4x4x4_16b_bf16 v[8:11], v[98:99], v[30:31], v[8:11]
    v_mfma_f32_4x4x4_16b_bf16 v[12:15], v[98:99], v[40:41], v[12:15]
    v_mfma_f32_4x4x4_16b_bf16 v[0:3], v[112:113], v[20:21], v[0:3]
    v_mfma_f32_4x4x4_16b_bf16 v[4:7], v[112:113], v[22:23], v[4:7]
    v_mfma_f32_4x4x4_16b_bf16 v[8:11], v[100:101], v[40:41], v[8:11]
    v_mfma_f32_4x4x4_16b_bf16 v[12:15], v[100:101], v[42:43], v[12:15]
    v_mfma_f32_4x4x4_16b_bf16 v[0:3], v[114:115], v[22:23], v[0:3]
    v_mfma_f32_4x4x4_16b_bf16 v[4:7], v[114:115], v[24:25], v[4:7]
    v_mfma_f32_4x4x4_16b_bf16 v[8:11], v[102:103], v[42:43], v[8:11]
    v_mfma_f32_4x4x4_16b_bf16 v[12:15], v[102:103], v[44:45], v[12:15]
    v_mfma_f32_4x4x4_16b_bf16 v[0:3], v[116:117], v[24:25], v[0:3]
    v_mfma_f32_4x4x4_16b_bf16 v[4:7], v[116:117], v[26:27], v[4:7]
    v_mfma_f32_4x4x4_16b_bf16 v[8:11], v[104:105], v[44:45], v[8:11]
    v_mfma_f32_4x4x4_16b_bf16 v[12:15], v[104:105], v[46:47], v[12:15]
    s_setprio 1
    ds_write_b128 v120, v[24:27]
    ds_write_b128 v120, v[44:47] offset:2816
    v_exp_f32 v32, v0
    v_exp_f32 v33, v1
    v_exp_f32 v34, v2
    v_exp_f32 v35, v3
    v_fma_f32 v32, v32, s32, s32
    v_fma_f32 v33, v33, s32, s32
    v_fma_f32 v34, v34, s32, s32
    v_fma_f32 v35, v35, s32, s32
    v_rcp_f32 v32, v32
    v_rcp_f32 v33, v33
    v_rcp_f32 v34, v34
    v_rcp_f32 v35, v35
    v_mul_f32 v0, v0, v32
    v_mul_f32 v1, v1, v33
    v_mul_f32 v2, v2, v34
    v_mul_f32 v3, v3, v35
    v_cvt_pk_bf16_f32 v0, v0, v1
    v_cvt_pk_bf16_f32 v1, v2, v3
    v_exp_f32 v36, v4
    v_exp_f32 v37, v5
    v_exp_f32 v38, v6
    v_exp_f32 v39, v7
    v_fma_f32 v36, v36, s32, s32
    v_fma_f32 v37, v37, s32, s32
    v_fma_f32 v38, v38, s32, s32
    v_fma_f32 v39, v39, s32, s32
    v_rcp_f32 v36, v36
    v_rcp_f32 v37, v37
    v_rcp_f32 v38, v38
    v_rcp_f32 v39, v39
    v_mul_f32 v4, v4, v36
    v_mul_f32 v5, v5, v37
    v_mul_f32 v6, v6, v38
    v_mul_f32 v7, v7, v39
    v_cvt_pk_bf16_f32 v2, v4, v5
    v_cvt_pk_bf16_f32 v3, v6, v7
    ds_write_b128 v121, v[0:3] offset:2048
    v_exp_f32 v32, v8
    v_exp_f32 v33, v9
    v_exp_f32 v34, v10
    v_exp_f32 v35, v11
    v_fma_f32 v32, v32, s32, s32
    v_fma_f32 v33, v33, s32, s32
    v_fma_f32 v34, v34, s32, s32
    v_fma_f32 v35, v35, s32, s32
    v_rcp_f32 v32, v32
    v_rcp_f32 v33, v33
    v_rcp_f32 v34, v34
    v_rcp_f32 v35, v35
    v_mul_f32 v8, v8, v32
    v_mul_f32 v9, v9, v33
    v_mul_f32 v10, v10, v34
    v_mul_f32 v11, v11, v35
    v_cvt_pk_bf16_f32 v8, v8, v9
    v_cvt_pk_bf16_f32 v9, v10, v11
    v_exp_f32 v36, v12
    v_exp_f32 v37, v13
    v_exp_f32 v38, v14
    v_exp_f32 v39, v15
    v_fma_f32 v36, v36, s32, s32
    v_fma_f32 v37, v37, s32, s32
    v_fma_f32 v38, v38, s32, s32
    v_fma_f32 v39, v39, s32, s32
    v_rcp_f32 v36, v36
    v_rcp_f32 v37, v37
    v_rcp_f32 v38, v38
    v_rcp_f32 v39, v39
    v_mul_f32 v12, v12, v36
    v_mul_f32 v13, v13, v37
    v_mul_f32 v14, v14, v38
    v_mul_f32 v15, v15, v39
    v_cvt_pk_bf16_f32 v10, v12, v13
    v_cvt_pk_bf16_f32 v11, v14, v15
    ds_write_b128 v121, v[8:11] offset:3072
    v_add_u32 v118, 0xa280, v118
    s_waitcnt lgkmcnt(0)
    s_barrier
    s_setprio 1
    ds_read_b128 v[80:83], v118
    ds_read_b128 v[84:87], v118 offset:16640
    s_waitcnt lgkmcnt(1)
    v_mfma_f32_32x32x16_bf16 v[16:31], v[80:83], a[0:3], 0
    ds_read_b128 v[88:91], v118 offset:32
    v_mfma_f32_32x32x16_bf16 v[32:47], v[80:83], a[4:7], 0
    s_waitcnt lgkmcnt(1)
    v_mfma_f32_32x32x16_bf16 v[64:79], v[84:87], a[4:7], 0
    ds_read_b128 v[92:95], v118 offset:16672
    v_mfma_f32_32x32x16_bf16 v[48:63], v[84:87], a[0:3], 0
    s_waitcnt lgkmcnt(1)
    v_mfma_f32_32x32x16_bf16 v[16:31], v[88:91], a[8:11], v[16:31]
    ds_read_b128 v[80:83], v118 offset:512
    v_mfma_f32_32x32x16_bf16 v[32:47], v[88:91], a[12:15], v[32:47]
    s_waitcnt lgkmcnt(1)
    v_mfma_f32_32x32x16_bf16 v[64:79], v[92:95], a[12:15], v[64:79]
    ds_read_b128 v[84:87], v118 offset:17152
    v_mfma_f32_32x32x16_bf16 v[48:63], v[92:95], a[8:11], v[48:63]
    s_waitcnt lgkmcnt(1)
    v_mfma_f32_32x32x16_bf16 v[16:31], v[80:83], a[16:19], v[16:31]
    ds_read_b128 v[88:91], v118 offset:544
    v_mfma_f32_32x32x16_bf16 v[32:47], v[80:83], a[20:23], v[32:47]
    s_waitcnt lgkmcnt(1)
    v_mfma_f32_32x32x16_bf16 v[64:79], v[84:87], a[20:23], v[64:79]
    ds_read_b128 v[92:95], v118 offset:17184
    v_mfma_f32_32x32x16_bf16 v[48:63], v[84:87], a[16:19], v[48:63]
    s_waitcnt lgkmcnt(1)
    v_mfma_f32_32x32x16_bf16 v[16:31], v[88:91], a[24:27], v[16:31]
    ds_read_b128 v[80:83], v118 offset:4160
    v_mfma_f32_32x32x16_bf16 v[32:47], v[88:91], a[28:31], v[32:47]
    s_waitcnt lgkmcnt(1)
    v_mfma_f32_32x32x16_bf16 v[64:79], v[92:95], a[28:31], v[64:79]
    ds_read_b128 v[84:87], v118 offset:20800
    v_mfma_f32_32x32x16_bf16 v[48:63], v[92:95], a[24:27], v[48:63]
    s_waitcnt lgkmcnt(1)
    v_mfma_f32_32x32x16_bf16 v[16:31], v[80:83], a[32:35], v[16:31]
    ds_read_b128 v[88:91], v118 offset:4192
    v_mfma_f32_32x32x16_bf16 v[32:47], v[80:83], a[36:39], v[32:47]
    s_waitcnt lgkmcnt(1)
    v_mfma_f32_32x32x16_bf16 v[64:79], v[84:87], a[36:39], v[64:79]
    ds_read_b128 v[92:95], v118 offset:20832
    v_mfma_f32_32x32x16_bf16 v[48:63], v[84:87], a[32:35], v[48:63]
    s_waitcnt lgkmcnt(1)
    v_mfma_f32_32x32x16_bf16 v[16:31], v[88:91], a[40:43], v[16:31]
    ds_read_b128 v[80:83], v118 offset:4672
    v_mfma_f32_32x32x16_bf16 v[32:47], v[88:91], a[44:47], v[32:47]
    s_waitcnt lgkmcnt(1)
    v_mfma_f32_32x32x16_bf16 v[64:79], v[92:95], a[44:47], v[64:79]
    ds_read_b128 v[84:87], v118 offset:21312
    v_mfma_f32_32x32x16_bf16 v[48:63], v[92:95], a[40:43], v[48:63]
    s_waitcnt lgkmcnt(1)
    v_mfma_f32_32x32x16_bf16 v[16:31], v[80:83], a[48:51], v[16:31]
    ds_read_b128 v[88:91], v118 offset:4704
    v_mfma_f32_32x32x16_bf16 v[32:47], v[80:83], a[52:55], v[32:47]
    s_waitcnt lgkmcnt(1)
    v_mfma_f32_32x32x16_bf16 v[64:79], v[84:87], a[52:55], v[64:79]
    ds_read_b128 v[92:95], v118 offset:21344
    v_mfma_f32_32x32x16_bf16 v[48:63], v[84:87], a[48:51], v[48:63]
    s_waitcnt lgkmcnt(1)
    v_mfma_f32_32x32x16_bf16 v[16:31], v[88:91], a[56:59], v[16:31]
    ds_read_b128 v[80:83], v118 offset:8320
    v_mfma_f32_32x32x16_bf16 v[32:47], v[88:91], a[60:63], v[32:47]
    s_waitcnt lgkmcnt(1)
    v_mfma_f32_32x32x16_bf16 v[64:79], v[92:95], a[60:63], v[64:79]
    ds_read_b128 v[84:87], v118 offset:24960
    v_mfma_f32_32x32x16_bf16 v[48:63], v[92:95], a[56:59], v[48:63]
    s_waitcnt lgkmcnt(1)
    v_mfma_f32_32x32x16_bf16 v[16:31], v[80:83], a[64:67], v[16:31]
    ds_read_b128 v[88:91], v118 offset:8352
    v_mfma_f32_32x32x16_bf16 v[32:47], v[80:83], a[68:71], v[32:47]
    s_waitcnt lgkmcnt(1)
    v_mfma_f32_32x32x16_bf16 v[64:79], v[84:87], a[68:71], v[64:79]
    ds_read_b128 v[92:95], v118 offset:24992
    v_mfma_f32_32x32x16_bf16 v[48:63], v[84:87], a[64:67], v[48:63]
    s_waitcnt lgkmcnt(1)
    v_mfma_f32_32x32x16_bf16 v[16:31], v[88:91], a[72:75], v[16:31]
    ds_read_b128 v[80:83], v118 offset:8832
    v_mfma_f32_32x32x16_bf16 v[32:47], v[88:91], a[76:79], v[32:47]
    s_waitcnt lgkmcnt(1)
    v_mfma_f32_32x32x16_bf16 v[64:79], v[92:95], a[76:79], v[64:79]
    ds_read_b128 v[84:87], v118 offset:25472
    v_mfma_f32_32x32x16_bf16 v[48:63], v[92:95], a[72:75], v[48:63]
    s_waitcnt lgkmcnt(1)
    v_mfma_f32_32x32x16_bf16 v[16:31], v[80:83], a[80:83], v[16:31]
    ds_read_b128 v[88:91], v118 offset:8864
    v_mfma_f32_32x32x16_bf16 v[32:47], v[80:83], a[84:87], v[32:47]
    s_waitcnt lgkmcnt(1)
    v_mfma_f32_32x32x16_bf16 v[64:79], v[84:87], a[84:87], v[64:79]
    ds_read_b128 v[92:95], v118 offset:25504
    v_mfma_f32_32x32x16_bf16 v[48:63], v[84:87], a[80:83], v[48:63]
    s_waitcnt lgkmcnt(1)
    v_mfma_f32_32x32x16_bf16 v[16:31], v[88:91], a[88:91], v[16:31]
    ds_read_b128 v[80:83], v118 offset:12480
    v_mfma_f32_32x32x16_bf16 v[32:47], v[88:91], a[92:95], v[32:47]
    s_waitcnt lgkmcnt(1)
    v_mfma_f32_32x32x16_bf16 v[64:79], v[92:95], a[92:95], v[64:79]
    ds_read_b128 v[84:87], v118 offset:29120
    v_mfma_f32_32x32x16_bf16 v[48:63], v[92:95], a[88:91], v[48:63]
    s_waitcnt lgkmcnt(1)
    v_mfma_f32_32x32x16_bf16 v[16:31], v[80:83], a[96:99], v[16:31]
    ds_read_b128 v[88:91], v118 offset:12512
    v_mfma_f32_32x32x16_bf16 v[32:47], v[80:83], a[100:103], v[32:47]
    s_waitcnt lgkmcnt(1)
    v_mfma_f32_32x32x16_bf16 v[64:79], v[84:87], a[100:103], v[64:79]
    ds_read_b128 v[92:95], v118 offset:29152
    v_mfma_f32_32x32x16_bf16 v[48:63], v[84:87], a[96:99], v[48:63]
    s_waitcnt lgkmcnt(1)
    v_mfma_f32_32x32x16_bf16 v[16:31], v[88:91], a[104:107], v[16:31]
    ds_read_b128 v[80:83], v118 offset:12992
    v_mfma_f32_32x32x16_bf16 v[32:47], v[88:91], a[108:111], v[32:47]
    s_waitcnt lgkmcnt(1)
    v_mfma_f32_32x32x16_bf16 v[64:79], v[92:95], a[108:111], v[64:79]
    ds_read_b128 v[84:87], v118 offset:29632
    v_mfma_f32_32x32x16_bf16 v[48:63], v[92:95], a[104:107], v[48:63]
    s_waitcnt lgkmcnt(1)
    v_mfma_f32_32x32x16_bf16 v[16:31], v[80:83], a[112:115], v[16:31]
    ds_read_b128 v[88:91], v118 offset:13024
    v_mfma_f32_32x32x16_bf16 v[32:47], v[80:83], a[116:119], v[32:47]
    s_waitcnt lgkmcnt(1)
    v_mfma_f32_32x32x16_bf16 v[64:79], v[84:87], a[116:119], v[64:79]
    ds_read_b128 v[92:95], v118 offset:29664
    v_mfma_f32_32x32x16_bf16 v[48:63], v[84:87], a[112:115], v[48:63]
    s_waitcnt lgkmcnt(1)
    v_mfma_f32_32x32x16_bf16 v[16:31], v[88:91], a[120:123], v[16:31]
    v_mfma_f32_32x32x16_bf16 v[32:47], v[88:91], a[124:127], v[32:47]
    s_waitcnt lgkmcnt(0)
    v_mfma_f32_32x32x16_bf16 v[64:79], v[92:95], a[124:127], v[64:79]
    v_mfma_f32_32x32x16_bf16 v[48:63], v[92:95], a[120:123], v[48:63]
    s_setprio 0
    s_sub_u32 s35, s34, s29
    s_add_u32 s35, s35, 0xa40
    v_add_u32 v121, s35, v121
    s_nop 4
    v_mul_f32 v32, s32, v32
    v_mul_f32 v33, s32, v33
    v_mul_f32 v34, s32, v34
    v_mul_f32 v35, s32, v35
    v_exp_f32 v32, v32
    v_exp_f32 v33, v33
    v_exp_f32 v34, v34
    v_exp_f32 v35, v35
    v_fma_f32 v32, v32, s33, s33
    v_fma_f32 v33, v33, s33, s33
    v_fma_f32 v34, v34, s33, s33
    v_fma_f32 v35, v35, s33, s33
    v_rcp_f32 v32, v32
    v_rcp_f32 v33, v33
    v_rcp_f32 v34, v34
    v_rcp_f32 v35, v35
    v_mul_f32 v16, v16, v32
    v_mul_f32 v17, v17, v33
    v_mul_f32 v18, v18, v34
    v_mul_f32 v19, v19, v35
    v_cvt_pk_bf16_f32 v32, v16, v17
    v_cvt_pk_bf16_f32 v33, v18, v19
    v_mul_f32 v36, s32, v36
    v_mul_f32 v37, s32, v37
    v_mul_f32 v38, s32, v38
    v_mul_f32 v39, s32, v39
    v_exp_f32 v36, v36
    v_exp_f32 v37, v37
    v_exp_f32 v38, v38
    v_exp_f32 v39, v39
    v_fma_f32 v36, v36, s33, s33
    v_fma_f32 v37, v37, s33, s33
    v_fma_f32 v38, v38, s33, s33
    v_fma_f32 v39, v39, s33, s33
    v_rcp_f32 v36, v36
    v_rcp_f32 v37, v37
    v_rcp_f32 v38, v38
    v_rcp_f32 v39, v39
    v_mul_f32 v20, v20, v36
    v_mul_f32 v21, v21, v37
    v_mul_f32 v22, v22, v38
    v_mul_f32 v23, v23, v39
    v_cvt_pk_bf16_f32 v34, v20, v21
    v_cvt_pk_bf16_f32 v35, v22, v23
    ds_write_b128 v119, v[32:35] offset:32
    v_mul_f32 v40, s32, v40
    v_mul_f32 v41, s32, v41
    v_mul_f32 v42, s32, v42
    v_mul_f32 v43, s32, v43
    v_exp_f32 v40, v40
    v_exp_f32 v41, v41
    v_exp_f32 v42, v42
    v_exp_f32 v43, v43
    v_fma_f32 v40, v40, s33, s33
    v_fma_f32 v41, v41, s33, s33
    v_fma_f32 v42, v42, s33, s33
    v_fma_f32 v43, v43, s33, s33
    v_rcp_f32 v40, v40
    v_rcp_f32 v41, v41
    v_rcp_f32 v42, v42
    v_rcp_f32 v43, v43
    v_mul_f32 v24, v24, v40
    v_mul_f32 v25, v25, v41
    v_mul_f32 v26, v26, v42
    v_mul_f32 v27, v27, v43
    v_cvt_pk_bf16_f32 v36, v24, v25
    v_cvt_pk_bf16_f32 v37, v26, v27
    v_mul_f32 v44, s32, v44
    v_mul_f32 v45, s32, v45
    v_mul_f32 v46, s32, v46
    v_mul_f32 v47, s32, v47
    v_exp_f32 v44, v44
    v_exp_f32 v45, v45
    v_exp_f32 v46, v46
    v_exp_f32 v47, v47
    v_fma_f32 v44, v44, s33, s33
    v_fma_f32 v45, v45, s33, s33
    v_fma_f32 v46, v46, s33, s33
    v_fma_f32 v47, v47, s33, s33
    v_rcp_f32 v44, v44
    v_rcp_f32 v45, v45
    v_rcp_f32 v46, v46
    v_rcp_f32 v47, v47
    v_mul_f32 v28, v28, v44
    v_mul_f32 v29, v29, v45
    v_mul_f32 v30, v30, v46
    v_mul_f32 v31, v31, v47
    v_cvt_pk_bf16_f32 v38, v28, v29
    v_cvt_pk_bf16_f32 v39, v30, v31
    ds_write_b128 v119, v[36:39] offset:48
    ds_read_b128 v[16:19], v120 offset:32
    ds_read_b128 v[28:31], v120 offset:2848
    ds_read_b128 v[20:23], v120 offset:48
    ds_read_b128 v[40:43], v120 offset:2864
    ds_read_b128 v[24:27], v120 offset:64
    ds_read_b128 v[44:47], v120 offset:2880
    v_mul_f32 v64, s32, v64
    v_mul_f32 v65, s32, v65
    v_mul_f32 v66, s32, v66
    v_mul_f32 v67, s32, v67
    v_exp_f32 v64, v64
    v_exp_f32 v65, v65
    v_exp_f32 v66, v66
    v_exp_f32 v67, v67
    v_fma_f32 v64, v64, s33, s33
    v_fma_f32 v65, v65, s33, s33
    v_fma_f32 v66, v66, s33, s33
    v_fma_f32 v67, v67, s33, s33
    v_rcp_f32 v64, v64
    v_rcp_f32 v65, v65
    v_rcp_f32 v66, v66
    v_rcp_f32 v67, v67
    v_mul_f32 v48, v48, v64
    v_mul_f32 v49, v49, v65
    v_mul_f32 v50, v50, v66
    v_mul_f32 v51, v51, v67
    v_cvt_pk_bf16_f32 v64, v48, v49
    v_cvt_pk_bf16_f32 v65, v50, v51
    v_mul_f32 v68, s32, v68
    v_mul_f32 v69, s32, v69
    v_mul_f32 v70, s32, v70
    v_mul_f32 v71, s32, v71
    v_exp_f32 v68, v68
    v_exp_f32 v69, v69
    v_exp_f32 v70, v70
    v_exp_f32 v71, v71
    v_fma_f32 v68, v68, s33, s33
    v_fma_f32 v69, v69, s33, s33
    v_fma_f32 v70, v70, s33, s33
    v_fma_f32 v71, v71, s33, s33
    v_rcp_f32 v68, v68
    v_rcp_f32 v69, v69
    v_rcp_f32 v70, v70
    v_rcp_f32 v71, v71
    v_mul_f32 v52, v52, v68
    v_mul_f32 v53, v53, v69
    v_mul_f32 v54, v54, v70
    v_mul_f32 v55, v55, v71
    v_cvt_pk_bf16_f32 v66, v52, v53
    v_cvt_pk_bf16_f32 v67, v54, v55
    ds_write_b128 v119, v[64:67] offset:96
    v_mul_f32 v72, s32, v72
    v_mul_f32 v73, s32, v73
    v_mul_f32 v74, s32, v74
    v_mul_f32 v75, s32, v75
    v_exp_f32 v72, v72
    v_exp_f32 v73, v73
    v_exp_f32 v74, v74
    v_exp_f32 v75, v75
    v_fma_f32 v72, v72, s33, s33
    v_fma_f32 v73, v73, s33, s33
    v_fma_f32 v74, v74, s33, s33
    v_fma_f32 v75, v75, s33, s33
    v_rcp_f32 v72, v72
    v_rcp_f32 v73, v73
    v_rcp_f32 v74, v74
    v_rcp_f32 v75, v75
    v_mul_f32 v56, v56, v72
    v_mul_f32 v57, v57, v73
    v_mul_f32 v58, v58, v74
    v_mul_f32 v59, v59, v75
    v_cvt_pk_bf16_f32 v68, v56, v57
    v_cvt_pk_bf16_f32 v69, v58, v59
    v_mul_f32 v76, s32, v76
    v_mul_f32 v77, s32, v77
    v_mul_f32 v78, s32, v78
    v_mul_f32 v79, s32, v79
    v_exp_f32 v76, v76
    v_exp_f32 v77, v77
    v_exp_f32 v78, v78
    v_exp_f32 v79, v79
    v_fma_f32 v76, v76, s33, s33
    v_fma_f32 v77, v77, s33, s33
    v_fma_f32 v78, v78, s33, s33
    v_fma_f32 v79, v79, s33, s33
    v_rcp_f32 v76, v76
    v_rcp_f32 v77, v77
    v_rcp_f32 v78, v78
    v_rcp_f32 v79, v79
    v_mul_f32 v60, v60, v76
    v_mul_f32 v61, v61, v77
    v_mul_f32 v62, v62, v78
    v_mul_f32 v63, v63, v79
    v_cvt_pk_bf16_f32 v70, v60, v61
    v_cvt_pk_bf16_f32 v71, v62, v63
    ds_write_b128 v119, v[68:71] offset:112
    s_setprio 3
    s_waitcnt lgkmcnt(1)
    v_mfma_f32_4x4x4_16b_bf16 v[0:3], v[108:109], v[16:17], 0
    v_mfma_f32_4x4x4_16b_bf16 v[4:7], v[108:109], v[18:19], 0
    v_mfma_f32_4x4x4_16b_bf16 v[8:11], v[96:97], v[28:29], 0
    v_mfma_f32_4x4x4_16b_bf16 v[12:15], v[96:97], v[30:31], 0
    v_mfma_f32_4x4x4_16b_bf16 v[0:3], v[110:111], v[18:19], v[0:3]
    v_mfma_f32_4x4x4_16b_bf16 v[4:7], v[110:111], v[20:21], v[4:7]
    v_mfma_f32_4x4x4_16b_bf16 v[8:11], v[98:99], v[30:31], v[8:11]
    v_mfma_f32_4x4x4_16b_bf16 v[12:15], v[98:99], v[40:41], v[12:15]
    v_mfma_f32_4x4x4_16b_bf16 v[0:3], v[112:113], v[20:21], v[0:3]
    v_mfma_f32_4x4x4_16b_bf16 v[4:7], v[112:113], v[22:23], v[4:7]
    v_mfma_f32_4x4x4_16b_bf16 v[8:11], v[100:101], v[40:41], v[8:11]
    v_mfma_f32_4x4x4_16b_bf16 v[12:15], v[100:101], v[42:43], v[12:15]
    v_mfma_f32_4x4x4_16b_bf16 v[0:3], v[114:115], v[22:23], v[0:3]
    v_mfma_f32_4x4x4_16b_bf16 v[4:7], v[114:115], v[24:25], v[4:7]
    v_mfma_f32_4x4x4_16b_bf16 v[8:11], v[102:103], v[42:43], v[8:11]
    v_mfma_f32_4x4x4_16b_bf16 v[12:15], v[102:103], v[44:45], v[12:15]
    v_mfma_f32_4x4x4_16b_bf16 v[0:3], v[116:117], v[24:25], v[0:3]
    v_mfma_f32_4x4x4_16b_bf16 v[4:7], v[116:117], v[26:27], v[4:7]
    v_mfma_f32_4x4x4_16b_bf16 v[8:11], v[104:105], v[44:45], v[8:11]
    v_mfma_f32_4x4x4_16b_bf16 v[12:15], v[104:105], v[46:47], v[12:15]
    s_setprio 0
    ds_read_b128 v[16:19], v120 offset:96
    ds_read_b128 v[28:31], v120 offset:2912
    ds_read_b128 v[20:23], v120 offset:112
    ds_read_b128 v[40:43], v120 offset:2928
    ds_read_b128 v[24:27], v120 offset:128
    ds_read_b128 v[44:47], v120 offset:2944
    v_exp_f32 v32, v0
    v_exp_f32 v33, v1
    v_exp_f32 v34, v2
    v_exp_f32 v35, v3
    v_fma_f32 v32, v32, s32, s32
    v_fma_f32 v33, v33, s32, s32
    v_fma_f32 v34, v34, s32, s32
    v_fma_f32 v35, v35, s32, s32
    v_rcp_f32 v32, v32
    v_rcp_f32 v33, v33
    v_rcp_f32 v34, v34
    v_rcp_f32 v35, v35
    v_mul_f32 v0, v0, v32
    v_mul_f32 v1, v1, v33
    v_mul_f32 v2, v2, v34
    v_mul_f32 v3, v3, v35
    v_cvt_pk_bf16_f32 v0, v0, v1
    v_cvt_pk_bf16_f32 v1, v2, v3
    v_exp_f32 v36, v4
    v_exp_f32 v37, v5
    v_exp_f32 v38, v6
    v_exp_f32 v39, v7
    v_fma_f32 v36, v36, s32, s32
    v_fma_f32 v37, v37, s32, s32
    v_fma_f32 v38, v38, s32, s32
    v_fma_f32 v39, v39, s32, s32
    v_rcp_f32 v36, v36
    v_rcp_f32 v37, v37
    v_rcp_f32 v38, v38
    v_rcp_f32 v39, v39
    v_mul_f32 v4, v4, v36
    v_mul_f32 v5, v5, v37
    v_mul_f32 v6, v6, v38
    v_mul_f32 v7, v7, v39
    v_cvt_pk_bf16_f32 v2, v4, v5
    v_cvt_pk_bf16_f32 v3, v6, v7
    ds_write_b128 v121, v[0:3]
    v_exp_f32 v32, v8
    v_exp_f32 v33, v9
    v_exp_f32 v34, v10
    v_exp_f32 v35, v11
    v_fma_f32 v32, v32, s32, s32
    v_fma_f32 v33, v33, s32, s32
    v_fma_f32 v34, v34, s32, s32
    v_fma_f32 v35, v35, s32, s32
    v_rcp_f32 v32, v32
    v_rcp_f32 v33, v33
    v_rcp_f32 v34, v34
    v_rcp_f32 v35, v35
    v_mul_f32 v8, v8, v32
    v_mul_f32 v9, v9, v33
    v_mul_f32 v10, v10, v34
    v_mul_f32 v11, v11, v35
    v_cvt_pk_bf16_f32 v8, v8, v9
    v_cvt_pk_bf16_f32 v9, v10, v11
    v_exp_f32 v36, v12
    v_exp_f32 v37, v13
    v_exp_f32 v38, v14
    v_exp_f32 v39, v15
    v_fma_f32 v36, v36, s32, s32
    v_fma_f32 v37, v37, s32, s32
    v_fma_f32 v38, v38, s32, s32
    v_fma_f32 v39, v39, s32, s32
    v_rcp_f32 v36, v36
    v_rcp_f32 v37, v37
    v_rcp_f32 v38, v38
    v_rcp_f32 v39, v39
    v_mul_f32 v12, v12, v36
    v_mul_f32 v13, v13, v37
    v_mul_f32 v14, v14, v38
    v_mul_f32 v15, v15, v39
    v_cvt_pk_bf16_f32 v10, v12, v13
    v_cvt_pk_bf16_f32 v11, v14, v15
    ds_write_b128 v121, v[8:11] offset:1024
    s_waitcnt lgkmcnt(0)
    s_barrier
    s_mul_i32 s35, s39, 0xffffdf60
    s_add_u32 s35, s35, 0x8200
    v_add_u32 v121, s35, v121
    s_setprio 3
    v_mfma_f32_4x4x4_16b_bf16 v[0:3], v[108:109], v[16:17], 0
    v_mfma_f32_4x4x4_16b_bf16 v[4:7], v[108:109], v[18:19], 0
    v_mfma_f32_4x4x4_16b_bf16 v[8:11], v[96:97], v[28:29], 0
    v_mfma_f32_4x4x4_16b_bf16 v[12:15], v[96:97], v[30:31], 0
    v_mfma_f32_4x4x4_16b_bf16 v[0:3], v[110:111], v[18:19], v[0:3]
    v_mfma_f32_4x4x4_16b_bf16 v[4:7], v[110:111], v[20:21], v[4:7]
    v_mfma_f32_4x4x4_16b_bf16 v[8:11], v[98:99], v[30:31], v[8:11]
    v_mfma_f32_4x4x4_16b_bf16 v[12:15], v[98:99], v[40:41], v[12:15]
    v_mfma_f32_4x4x4_16b_bf16 v[0:3], v[112:113], v[20:21], v[0:3]
    v_mfma_f32_4x4x4_16b_bf16 v[4:7], v[112:113], v[22:23], v[4:7]
    v_mfma_f32_4x4x4_16b_bf16 v[8:11], v[100:101], v[40:41], v[8:11]
    v_mfma_f32_4x4x4_16b_bf16 v[12:15], v[100:101], v[42:43], v[12:15]
    v_mfma_f32_4x4x4_16b_bf16 v[0:3], v[114:115], v[22:23], v[0:3]
    v_mfma_f32_4x4x4_16b_bf16 v[4:7], v[114:115], v[24:25], v[4:7]
    v_mfma_f32_4x4x4_16b_bf16 v[8:11], v[102:103], v[42:43], v[8:11]
    v_mfma_f32_4x4x4_16b_bf16 v[12:15], v[102:103], v[44:45], v[12:15]
    v_mfma_f32_4x4x4_16b_bf16 v[0:3], v[116:117], v[24:25], v[0:3]
    v_mfma_f32_4x4x4_16b_bf16 v[4:7], v[116:117], v[26:27], v[4:7]
    v_mfma_f32_4x4x4_16b_bf16 v[8:11], v[104:105], v[44:45], v[8:11]
    v_mfma_f32_4x4x4_16b_bf16 v[12:15], v[104:105], v[46:47], v[12:15]
    s_setprio 0
    v_mbcnt_lo_u32_b32 v48, -1, 0
    v_mbcnt_hi_u32_b32 v48, -1, v48
    s_add_u32 s40, s34, 0x107f
    s_and_b32 s40, s40, 0xffffff80
    s_lshl_b32 s35, s39, 7
    v_lshrrev_b32 v49, 3, v48
    v_and_b32 v50, 7, v48
    v_xor_b32 v50, v50, v49
    v_lshlrev_b32 v106, 4, v48
    v_add_u32 v106, s40, v106
    v_lshlrev_b32 v107, 9, v49
    v_lshl_add_u32 v107, v50, 4, v107
    v_add_u32 v107, s35, v107
    s_barrier
    ds_read_b128 v[64:67], v106
    ds_read_b128 v[68:71], v106 offset:1024
    ds_read_b128 v[72:75], v106 offset:2048
    ds_read_b128 v[76:79], v106 offset:3072
    s_mov_b32 s30, 0x4000
    s_waitcnt lgkmcnt(3)
    buffer_store_dwordx4 v[64:67], v107, s[20:23], s30 offen sc1
    s_mov_b32 s30, 0x5000
    s_waitcnt lgkmcnt(2)
    buffer_store_dwordx4 v[68:71], v107, s[20:23], s30 offen sc1
    s_mov_b32 s30, 0x6000
    s_waitcnt lgkmcnt(1)
    buffer_store_dwordx4 v[72:75], v107, s[20:23], s30 offen sc1
    s_mov_b32 s30, 0x7000
    s_waitcnt lgkmcnt(0)
    buffer_store_dwordx4 v[76:79], v107, s[20:23], s30 offen sc1
    v_exp_f32 v32, v0
    v_exp_f32 v33, v1
    v_exp_f32 v34, v2
    v_exp_f32 v35, v3
    v_fma_f32 v32, v32, s32, s32
    v_fma_f32 v33, v33, s32, s32
    v_fma_f32 v34, v34, s32, s32
    v_fma_f32 v35, v35, s32, s32
    v_rcp_f32 v32, v32
    v_rcp_f32 v33, v33
    v_rcp_f32 v34, v34
    v_rcp_f32 v35, v35
    v_mul_f32 v0, v0, v32
    v_mul_f32 v1, v1, v33
    v_mul_f32 v2, v2, v34
    v_mul_f32 v3, v3, v35
    v_cvt_pk_bf16_f32 v0, v0, v1
    v_cvt_pk_bf16_f32 v1, v2, v3
    v_exp_f32 v36, v4
    v_exp_f32 v37, v5
    v_exp_f32 v38, v6
    v_exp_f32 v39, v7
    v_fma_f32 v36, v36, s32, s32
    v_fma_f32 v37, v37, s32, s32
    v_fma_f32 v38, v38, s32, s32
    v_fma_f32 v39, v39, s32, s32
    v_rcp_f32 v36, v36
    v_rcp_f32 v37, v37
    v_rcp_f32 v38, v38
    v_rcp_f32 v39, v39
    v_mul_f32 v4, v4, v36
    v_mul_f32 v5, v5, v37
    v_mul_f32 v6, v6, v38
    v_mul_f32 v7, v7, v39
    v_cvt_pk_bf16_f32 v2, v4, v5
    v_cvt_pk_bf16_f32 v3, v6, v7
    ds_write_b128 v121, v[0:3]
    v_exp_f32 v32, v8
    v_exp_f32 v33, v9
    v_exp_f32 v34, v10
    v_exp_f32 v35, v11
    v_fma_f32 v32, v32, s32, s32
    v_fma_f32 v33, v33, s32, s32
    v_fma_f32 v34, v34, s32, s32
    v_fma_f32 v35, v35, s32, s32
    v_rcp_f32 v32, v32
    v_rcp_f32 v33, v33
    v_rcp_f32 v34, v34
    v_rcp_f32 v35, v35
    v_mul_f32 v8, v8, v32
    v_mul_f32 v9, v9, v33
    v_mul_f32 v10, v10, v34
    v_mul_f32 v11, v11, v35
    v_cvt_pk_bf16_f32 v8, v8, v9
    v_cvt_pk_bf16_f32 v9, v10, v11
    v_exp_f32 v36, v12
    v_exp_f32 v37, v13
    v_exp_f32 v38, v14
    v_exp_f32 v39, v15
    v_fma_f32 v36, v36, s32, s32
    v_fma_f32 v37, v37, s32, s32
    v_fma_f32 v38, v38, s32, s32
    v_fma_f32 v39, v39, s32, s32
    v_rcp_f32 v36, v36
    v_rcp_f32 v37, v37
    v_rcp_f32 v38, v38
    v_rcp_f32 v39, v39
    v_mul_f32 v12, v12, v36
    v_mul_f32 v13, v13, v37
    v_mul_f32 v14, v14, v38
    v_mul_f32 v15, v15, v39
    v_cvt_pk_bf16_f32 v10, v12, v13
    v_cvt_pk_bf16_f32 v11, v14, v15
    ds_write_b128 v121, v[8:11] offset:1024
    s_waitcnt lgkmcnt(0)
    s_barrier
    ds_read_b128 v[48:51], v106 offset:45696
    ds_read_b128 v[52:55], v106 offset:46720
    ds_read_b128 v[56:59], v106 offset:47744
    ds_read_b128 v[60:63], v106 offset:48768
    s_mov_b32 s30, 0x8000
    s_waitcnt lgkmcnt(3)
    buffer_store_dwordx4 v[48:51], v107, s[20:23], s30 offen sc1
    s_mov_b32 s30, 0x9000
    s_waitcnt lgkmcnt(2)
    buffer_store_dwordx4 v[52:55], v107, s[20:23], s30 offen sc1
    s_mov_b32 s30, 0xa000
    s_waitcnt lgkmcnt(1)
    buffer_store_dwordx4 v[56:59], v107, s[20:23], s30 offen sc1
    s_mov_b32 s30, 0xb000
    s_waitcnt lgkmcnt(0)
    buffer_store_dwordx4 v[60:63], v107, s[20:23], s30 offen sc1
    s_endpgm
L_END:
    s_endpgm
.section .rodata,"a"
.p2align 6
.amdhsa_kernel standalone__conformer_conv_module__speech_kernel
  .amdhsa_next_free_vgpr 256
  .amdhsa_next_free_sgpr 102
  .amdhsa_accum_offset 128
  .amdhsa_group_segment_fixed_size 0
  .amdhsa_kernarg_size 56
  .amdhsa_user_sgpr_count 2
  .amdhsa_user_sgpr_kernarg_segment_ptr 1
  .amdhsa_system_sgpr_workgroup_id_x 1
.end_amdhsa_kernel
```
